```python
import torch

def _softmax(x, axis=-1):
    return torch.softmax(x, dim=axis)
def _gelu(x):
    return torch.nn.functional.gelu(x, approximate="tanh")
def _silu(x):
    return torch.nn.functional.silu(x)
def _sigmoid(x):
    return torch.sigmoid(x)
def _layernorm(x, axis=-1, eps=1e-5):
    m = x.mean(dim=axis, keepdim=True)
    v = x.var(dim=axis, keepdim=True, unbiased=False)
    return (x - m) / torch.sqrt(v + eps)
def _scatter_add(tgt, idx, src, axis=0):
    return tgt.clone().index_add_(axis, idx, src)
def _segment_sum(src, seg, n):
    out = torch.zeros((n,) + src.shape[1:], dtype=src.dtype)
    return out.index_add_(0, seg, src)
def _pad(x, pw):
    flat = tuple(v for pair in reversed(pw) for v in pair)
    return torch.nn.functional.pad(x, flat)

kernel_name = 'standalone__gqa_block_cached__sampling'

def setup_inputs():

    _w = (lambda a: (lambda t: t.to(torch.bfloat16) if t.is_floating_point() else t)(torch.as_tensor(a)))
    B, Sq, D = 8, 1, 448
    Hq, Hkv, Sk, Dh = 16, 8, 8192, 256
    assert Hq % Hkv == 0, (Hq, Hkv)
    return {
        "x": _w((lambda *s: torch.randn(*s, dtype=torch.bfloat16) * 0.8)(B, Sq, D)),
        "k_cache": _w((lambda *s: torch.randn(*s, dtype=torch.bfloat16) * 0.8)(B, Hkv, Sk, Dh)),
        "v_cache": _w((lambda *s: torch.randn(*s, dtype=torch.bfloat16) * 0.05)(B, Hkv, Sk, Dh)),
        "wq": _w((lambda *s: torch.randn(*s, dtype=torch.bfloat16) * 0.8)(D, Hq * Dh) * (D ** -0.5)),
        "wo": _w((lambda *s: torch.randn(*s, dtype=torch.bfloat16) * 0.05)(Hq * Dh, D) * ((Hq * Dh) ** -0.5)),
    }

def reference(x, k_cache, v_cache, wq, wo):
    B, Sq, D = x.shape
    Hq, Dh = 16, 256
    Hkv = k_cache.shape[1]
    rep = Hq // Hkv
    q = (lambda x, *d: x.permute(*d))((x @ wq).reshape(B, Sq, Hq, Dh), 0, 2, 1, 3)
    k = (lambda x, n, axis: torch.repeat_interleave(x, n, dim=axis))(k_cache, rep, axis=1)
    v = (lambda x, n, axis: torch.repeat_interleave(x, n, dim=axis))(v_cache, rep, axis=1)
    scores = torch.einsum("bhqd,bhkd->bhqk", q, k) * (Dh ** -0.5)
    p = _softmax(scores, axis=-1)
    o = torch.einsum("bhqk,bhkd->bhqd", p, v)
    return (lambda x, *d: x.permute(*d))(o, 0, 2, 1, 3).reshape(B, Sq, Hq * Dh) @ wo
```

```asm
; @launch grid=(256,1,1) block=(256,1,1) lds=84480
.amdgcn_target "amdgcn-amd-amdhsa--gfx950"
.text
.globl standalone__gqa_block_cached__sampling_kernel
.p2align 8
.type standalone__gqa_block_cached__sampling_kernel,@function
standalone__gqa_block_cached__sampling_kernel:
    s_cmp_ge_u32 s2, 256
    s_cbranch_scc1 M_end
    s_load_dwordx16 s[4:19], s[0:1], 0
    s_and_b32 s70, s2, 7
    s_lshl_b32 s70, s70, 2
    s_bfe_u32 s71, s2, 131075
    s_and_b32 s2, s2, 0xe0
    s_or_b32 s2, s2, s70
    s_or_b32 s2, s2, s71
    v_lshrrev_b32 v7, 6, v0
    v_and_b32 v0, 63, v0
    v_readfirstlane_b32 s3, v7
    v_mov_b32 v8, 25856
    v_mov_b32 v16, 0
    v_mov_b32 v17, 0
    v_mov_b32 v18, 0
    v_mov_b32 v19, 0
    ds_write_b128 v8, v[16:19]
    ds_write_b128 v8, v[16:19] offset:16
    v_and_b32 v46, 15, v0
    v_lshrrev_b32 v47, 4, v0
    v_lshlrev_b32 v1, 9, v46
    v_lshl_add_u32 v1, v47, 4, v1
    v_lshlrev_b32 v2, 11, v47
    v_lshl_add_u32 v2, v46, 4, v2
    s_lshl_b32 s57, s2, 20
    s_lshl_b32 s59, s3, 15
    s_add_u32 s57, s57, s59
    s_mov_b32 s58, s57
    s_mov_b32 s22, 0x10000000
    s_mov_b32 s23, 0x00020000
    s_mov_b32 s26, 0x10000000
    s_mov_b32 s27, 0x00020000
    s_mov_b32 s30, 0x330000
    s_mov_b32 s31, 0x00020000
    s_mov_b32 s34, 0x1c00
    s_mov_b32 s35, 0x00020000
    s_mov_b32 s38, 0x380000
    s_mov_b32 s39, 0x00020000
    s_mov_b32 s42, 0x380000
    s_mov_b32 s43, 0x00020000
    s_mov_b32 s46, 0x1c00
    s_mov_b32 s47, 0x00020000
    s_mov_b32 s62, 262144
    s_mov_b32 s54, 0x3db8aa3b
    s_mov_b32 s55, 0x05040100
    s_mov_b32 s56, 0x07060302
    s_waitcnt lgkmcnt(0)
    s_mov_b64 s[32:33], s[4:5]
    s_mov_b64 s[36:37], s[10:11]
    s_mov_b64 s[20:21], s[6:7]
    s_mov_b64 s[24:25], s[8:9]
    s_mov_b64 s[28:29], s[18:19]
    s_mov_b64 s[40:41], s[12:13]
    s_mov_b64 s[44:45], s[14:15]
    s_cmp_eq_u32 s3, 2
    s_cbranch_scc1 M_w2
    s_barrier
    s_cmp_eq_u32 s3, 1
    s_cbranch_scc1 M_w1
    s_cmp_eq_u32 s3, 3
    s_cbranch_scc1 M_w3
M_w0:
    s_add_u32 s59, s57, 8192
    buffer_load_dwordx4 a[0:3], v1, s[20:23], s57 offen offset:0 nt
    buffer_load_dwordx4 a[4:7], v1, s[20:23], s57 offen offset:64 nt
    buffer_load_dwordx4 a[8:11], v1, s[20:23], s57 offen offset:128 nt
    buffer_load_dwordx4 a[12:15], v1, s[20:23], s57 offen offset:192 nt
    buffer_load_dwordx4 a[16:19], v1, s[20:23], s57 offen offset:256 nt
    buffer_load_dwordx4 a[20:23], v1, s[20:23], s57 offen offset:320 nt
    buffer_load_dwordx4 a[24:27], v1, s[20:23], s57 offen offset:384 nt
    buffer_load_dwordx4 a[28:31], v1, s[20:23], s57 offen offset:448 nt
    buffer_load_dwordx4 a[32:35], v1, s[20:23], s59 offen offset:0 nt
    buffer_load_dwordx4 a[36:39], v1, s[20:23], s59 offen offset:64 nt
    buffer_load_dwordx4 a[40:43], v1, s[20:23], s59 offen offset:128 nt
    buffer_load_dwordx4 a[44:47], v1, s[20:23], s59 offen offset:192 nt
    buffer_load_dwordx4 a[48:51], v1, s[20:23], s59 offen offset:256 nt
    buffer_load_dwordx4 a[52:55], v1, s[20:23], s59 offen offset:320 nt
    buffer_load_dwordx4 a[56:59], v1, s[20:23], s59 offen offset:384 nt
    buffer_load_dwordx4 a[60:63], v1, s[20:23], s59 offen offset:448 nt
    s_add_u32 s57, s57, 16384
    s_add_u32 s60, s58, 8192
    buffer_load_dwordx4 v[48:51], v2, s[24:27], s58 offen offset:0 nt
    buffer_load_dwordx4 v[80:83], v2, s[24:27], s58 offen offset:256 nt
    buffer_load_dwordx4 v[52:55], v2, s[24:27], s58 offen offset:512 nt
    buffer_load_dwordx4 v[84:87], v2, s[24:27], s58 offen offset:768 nt
    buffer_load_dwordx4 v[56:59], v2, s[24:27], s58 offen offset:1024 nt
    buffer_load_dwordx4 v[88:91], v2, s[24:27], s58 offen offset:1280 nt
    buffer_load_dwordx4 v[60:63], v2, s[24:27], s58 offen offset:1536 nt
    buffer_load_dwordx4 v[92:95], v2, s[24:27], s58 offen offset:1792 nt
    buffer_load_dwordx4 v[64:67], v2, s[24:27], s60 offen offset:0 nt
    buffer_load_dwordx4 v[96:99], v2, s[24:27], s60 offen offset:256 nt
    buffer_load_dwordx4 v[68:71], v2, s[24:27], s60 offen offset:512 nt
    buffer_load_dwordx4 v[100:103], v2, s[24:27], s60 offen offset:768 nt
    buffer_load_dwordx4 v[72:75], v2, s[24:27], s60 offen offset:1024 nt
    buffer_load_dwordx4 v[104:107], v2, s[24:27], s60 offen offset:1280 nt
    buffer_load_dwordx4 v[76:79], v2, s[24:27], s60 offen offset:1536 nt
    buffer_load_dwordx4 v[108:111], v2, s[24:27], s60 offen offset:1792 nt
    s_add_u32 s58, s58, 16384
    s_waitcnt vmcnt(16)
    s_add_u32 s59, s57, 8192
    buffer_load_dwordx4 a[64:67], v1, s[20:23], s57 offen offset:0 nt
    buffer_load_dwordx4 a[68:71], v1, s[20:23], s57 offen offset:64 nt
    buffer_load_dwordx4 a[72:75], v1, s[20:23], s57 offen offset:128 nt
    buffer_load_dwordx4 a[76:79], v1, s[20:23], s57 offen offset:192 nt
    buffer_load_dwordx4 a[80:83], v1, s[20:23], s57 offen offset:256 nt
    buffer_load_dwordx4 a[84:87], v1, s[20:23], s57 offen offset:320 nt
    buffer_load_dwordx4 a[88:91], v1, s[20:23], s57 offen offset:384 nt
    buffer_load_dwordx4 a[92:95], v1, s[20:23], s57 offen offset:448 nt
    buffer_load_dwordx4 a[96:99], v1, s[20:23], s59 offen offset:0 nt
    buffer_load_dwordx4 a[100:103], v1, s[20:23], s59 offen offset:64 nt
    buffer_load_dwordx4 a[104:107], v1, s[20:23], s59 offen offset:128 nt
    buffer_load_dwordx4 a[108:111], v1, s[20:23], s59 offen offset:192 nt
    buffer_load_dwordx4 a[112:115], v1, s[20:23], s59 offen offset:256 nt
    buffer_load_dwordx4 a[116:119], v1, s[20:23], s59 offen offset:320 nt
    buffer_load_dwordx4 a[120:123], v1, s[20:23], s59 offen offset:384 nt
    buffer_load_dwordx4 a[124:127], v1, s[20:23], s59 offen offset:448 nt
    s_add_u32 s57, s57, 49152
    s_waitcnt vmcnt(16)
    s_add_u32 s60, s58, 8192
    buffer_load_dwordx4 v[112:115], v2, s[24:27], s58 offen offset:0 nt
    buffer_load_dwordx4 v[144:147], v2, s[24:27], s58 offen offset:256 nt
    buffer_load_dwordx4 v[116:119], v2, s[24:27], s58 offen offset:512 nt
    buffer_load_dwordx4 v[148:151], v2, s[24:27], s58 offen offset:768 nt
    buffer_load_dwordx4 v[120:123], v2, s[24:27], s58 offen offset:1024 nt
    buffer_load_dwordx4 v[152:155], v2, s[24:27], s58 offen offset:1280 nt
    buffer_load_dwordx4 v[124:127], v2, s[24:27], s58 offen offset:1536 nt
    buffer_load_dwordx4 v[156:159], v2, s[24:27], s58 offen offset:1792 nt
    buffer_load_dwordx4 v[128:131], v2, s[24:27], s60 offen offset:0 nt
    buffer_load_dwordx4 v[160:163], v2, s[24:27], s60 offen offset:256 nt
    buffer_load_dwordx4 v[132:135], v2, s[24:27], s60 offen offset:512 nt
    buffer_load_dwordx4 v[164:167], v2, s[24:27], s60 offen offset:768 nt
    buffer_load_dwordx4 v[136:139], v2, s[24:27], s60 offen offset:1024 nt
    buffer_load_dwordx4 v[168:171], v2, s[24:27], s60 offen offset:1280 nt
    buffer_load_dwordx4 v[140:143], v2, s[24:27], s60 offen offset:1536 nt
    buffer_load_dwordx4 v[172:175], v2, s[24:27], s60 offen offset:1792 nt
    s_add_u32 s58, s58, 49152
    v_mov_b32 v3, 0xff7fffff
    v_mov_b32 v4, 0
    v_and_b32 v7, 2, v46
    v_cmp_eq_u32 vcc, 0, v7
    v_and_b32 v8, 1, v47
    v_and_b32 v9, 2, v47
    v_cmp_ne_u32 s[64:65], 0, v8
    v_cmp_ne_u32 s[66:67], 0, v9
    v_cndmask_b32 v5, 0, -1, vcc
    v_not_b32 v6, v5
    v_mov_b32 v176, 0
    v_mov_b32 v177, 0
    v_mov_b32 v178, 0
    v_mov_b32 v179, 0
    v_mov_b32 v180, 0
    v_mov_b32 v181, 0
    v_mov_b32 v182, 0
    v_mov_b32 v183, 0
    v_mov_b32 v184, 0
    v_mov_b32 v185, 0
    v_mov_b32 v186, 0
    v_mov_b32 v187, 0
    v_mov_b32 v188, 0
    v_mov_b32 v189, 0
    v_mov_b32 v190, 0
    v_mov_b32 v191, 0
    v_mov_b32 v192, 0
    v_mov_b32 v193, 0
    v_mov_b32 v194, 0
    v_mov_b32 v195, 0
    v_mov_b32 v196, 0
    v_mov_b32 v197, 0
    v_mov_b32 v198, 0
    v_mov_b32 v199, 0
    v_mov_b32 v200, 0
    v_mov_b32 v201, 0
    v_mov_b32 v202, 0
    v_mov_b32 v203, 0
    v_mov_b32 v204, 0
    v_mov_b32 v205, 0
    v_mov_b32 v206, 0
    v_mov_b32 v207, 0
    s_waitcnt vmcnt(16)
    v_mov_b32 v8, 25864
    v_mov_b32 v9, 1
    ds_write_b32 v8, v9
    v_mov_b32 v8, 25856
    s_mov_b32 s75, 2097152
W_1:
    ds_read_b128 v[32:35], v8 offset:0
    s_sub_u32 s75, s75, 1
    s_cmp_eq_u32 s75, 0
    s_cbranch_scc1 M_end
    s_waitcnt lgkmcnt(0)
    v_readfirstlane_b32 s79, v32
    v_readfirstlane_b32 s52, v33
    s_cmp_lg_u32 s79, 0
    s_cbranch_scc1 K_2
    s_sleep 1
    s_branch W_1
K_2:
    v_and_b32 v7, 1, v46
    v_lshlrev_b32 v7, 9, v7
    v_lshl_add_u32 v7, v47, 4, v7
    ds_read_b128 a[128:131], v7 offset:26112
    ds_read_b128 a[132:135], v7 offset:26176
    ds_read_b128 a[136:139], v7 offset:26240
    ds_read_b128 a[140:143], v7 offset:26304
    ds_read_b128 a[144:147], v7 offset:26368
    ds_read_b128 a[148:151], v7 offset:26432
    ds_read_b128 a[152:155], v7 offset:26496
    ds_read_b128 a[156:159], v7 offset:26560
    s_waitcnt lgkmcnt(0)
    v_mov_b32 v209, s52
    v_mov_b32 v211, s52
    v_mov_b32 v213, s52
    v_mov_b32 v215, s52
    v_mov_b32 v217, s52
    v_mov_b32 v219, s52
    v_mov_b32 v221, s52
    v_mov_b32 v223, s52
    v_mov_b32 v225, s52
    v_mov_b32 v227, s52
    v_lshlrev_b32 v15, 4, v0
    s_mov_b32 s48, s57
    s_mov_b32 s49, 4
    s_lshr_b32 s70, s2, 2
    s_lshl_b32 s51, s70, 22
    s_add_u32 s51, s51, 999424
    s_lshl_b32 s70, s70, 8
    s_add_u32 s70, s70, 196608
    s_add_u32 s68, s18, s70
    s_addc_u32 s69, s19, 0
    s_mov_b32 s50, 12
M_loop:
    s_cmp_lt_u32 s49, 61
    s_cbranch_scc1 NS_3
    s_waitcnt lgkmcnt(0)
    s_cmp_ge_u32 s50, 12
    s_cbranch_scc1 M_drain0
    s_and_b32 s70, s50, 3
    s_lshl_b32 s70, s70, 20
    s_lshr_b32 s71, s50, 2
    s_lshl_b32 s71, s71, 14
    s_add_u32 s57, s51, s70
    s_add_u32 s57, s57, s71
    s_mov_b32 s50, 1
    s_atomic_add s50, s[68:69], 0 glc
    s_branch NJ_4
NS_3:
    s_mov_b32 s57, s48
    s_add_u32 s48, s48, 16384
    s_add_u32 s49, s49, 1
    s_cmp_eq_u32 s49, 41
    s_cbranch_scc1 M_merge
M_merged:
    s_cmp_lg_u32 s49, 61
    s_cbranch_scc1 NJ_4
    s_mov_b32 s50, 1
    s_atomic_add s50, s[68:69], 0 glc
NJ_4:
    s_mov_b32 s58, s57
    s_waitcnt vmcnt(48)
    s_add_u32 s59, s57, 8192
    v_mfma_f32_16x16x32_bf16 v[16:19], a[0:3], a[128:131], 0
    buffer_load_dwordx4 a[0:3], v1, s[20:23], s57 offen offset:0 nt
    v_mfma_f32_16x16x32_bf16 v[16:19], a[4:7], a[132:135], v[16:19]
    buffer_load_dwordx4 a[4:7], v1, s[20:23], s57 offen offset:64 nt
    v_mfma_f32_16x16x32_bf16 v[16:19], a[8:11], a[136:139], v[16:19]
    buffer_load_dwordx4 a[8:11], v1, s[20:23], s57 offen offset:128 nt
    v_mfma_f32_16x16x32_bf16 v[16:19], a[12:15], a[140:143], v[16:19]
    buffer_load_dwordx4 a[12:15], v1, s[20:23], s57 offen offset:192 nt
    v_mfma_f32_16x16x32_bf16 v[16:19], a[16:19], a[144:147], v[16:19]
    buffer_load_dwordx4 a[16:19], v1, s[20:23], s57 offen offset:256 nt
    v_mfma_f32_16x16x32_bf16 v[16:19], a[20:23], a[148:151], v[16:19]
    buffer_load_dwordx4 a[20:23], v1, s[20:23], s57 offen offset:320 nt
    v_mfma_f32_16x16x32_bf16 v[16:19], a[24:27], a[152:155], v[16:19]
    buffer_load_dwordx4 a[24:27], v1, s[20:23], s57 offen offset:384 nt
    v_mfma_f32_16x16x32_bf16 v[16:19], a[28:31], a[156:159], v[16:19]
    buffer_load_dwordx4 a[28:31], v1, s[20:23], s57 offen offset:448 nt
    v_mfma_f32_16x16x32_bf16 v[20:23], a[32:35], a[128:131], 0
    buffer_load_dwordx4 a[32:35], v1, s[20:23], s59 offen offset:0 nt
    v_mfma_f32_16x16x32_bf16 v[20:23], a[36:39], a[132:135], v[20:23]
    buffer_load_dwordx4 a[36:39], v1, s[20:23], s59 offen offset:64 nt
    v_mfma_f32_16x16x32_bf16 v[20:23], a[40:43], a[136:139], v[20:23]
    buffer_load_dwordx4 a[40:43], v1, s[20:23], s59 offen offset:128 nt
    v_mfma_f32_16x16x32_bf16 v[20:23], a[44:47], a[140:143], v[20:23]
    buffer_load_dwordx4 a[44:47], v1, s[20:23], s59 offen offset:192 nt
    v_mfma_f32_16x16x32_bf16 v[20:23], a[48:51], a[144:147], v[20:23]
    buffer_load_dwordx4 a[48:51], v1, s[20:23], s59 offen offset:256 nt
    v_mfma_f32_16x16x32_bf16 v[20:23], a[52:55], a[148:151], v[20:23]
    buffer_load_dwordx4 a[52:55], v1, s[20:23], s59 offen offset:320 nt
    v_mfma_f32_16x16x32_bf16 v[20:23], a[56:59], a[152:155], v[20:23]
    buffer_load_dwordx4 a[56:59], v1, s[20:23], s59 offen offset:384 nt
    v_mfma_f32_16x16x32_bf16 v[20:23], a[60:63], a[156:159], v[20:23]
    buffer_load_dwordx4 a[60:63], v1, s[20:23], s59 offen offset:448 nt
    s_add_u32 s57, s57, 16384
    s_nop 5
    v_cvt_pk_bf16_f32 v24, v16, v17
    v_cvt_pk_bf16_f32 v25, v18, v19
    v_cvt_pk_bf16_f32 v26, v20, v21
    v_cvt_pk_bf16_f32 v27, v22, v23
    v_lshlrev_b32 v16, 16, v24
    v_and_b32 v17, 0xffff0000, v24
    v_lshlrev_b32 v18, 16, v25
    v_and_b32 v19, 0xffff0000, v25
    v_lshlrev_b32 v20, 16, v26
    v_and_b32 v21, 0xffff0000, v26
    v_lshlrev_b32 v22, 16, v27
    v_and_b32 v23, 0xffff0000, v27
    v_max3_f32 v7, v16, v17, v18
    v_max3_f32 v7, v7, v19, v20
    v_max3_f32 v7, v7, v21, v22
    v_max_f32 v7, v7, v23
    v_mov_b32 v8, v7
    s_nop 1
    v_permlane16_swap_b32 v7, v8
    s_nop 0
    v_max_f32 v7, v7, v8
    v_mov_b32 v8, v7
    s_nop 1
    v_permlane32_swap_b32 v7, v8
    s_nop 0
    v_max_f32 v7, v7, v8
    v_mul_f32 v7, s54, v7
    v_max_f32 v7, v3, v7
    v_sub_f32 v8, v3, v7
    v_exp_f32 v10, v8
    v_mov_b32 v3, v7
    v_fma_f32 v16, v16, s54, -v7
    v_fma_f32 v17, v17, s54, -v7
    v_fma_f32 v18, v18, s54, -v7
    v_fma_f32 v19, v19, s54, -v7
    v_fma_f32 v20, v20, s54, -v7
    v_fma_f32 v21, v21, s54, -v7
    v_fma_f32 v22, v22, s54, -v7
    v_fma_f32 v23, v23, s54, -v7
    v_exp_f32 v16, v16
    v_exp_f32 v17, v17
    v_exp_f32 v18, v18
    v_exp_f32 v19, v19
    v_exp_f32 v20, v20
    v_exp_f32 v21, v21
    v_exp_f32 v22, v22
    v_exp_f32 v23, v23
    v_mov_b32_dpp v44, v10 quad_perm:[0,0,2,2] row_mask:0xf bank_mask:0xf
    v_mov_b32_dpp v45, v10 quad_perm:[1,1,3,3] row_mask:0xf bank_mask:0xf
    v_cvt_pk_bf16_f32 v28, v16, v17
    v_cvt_pk_bf16_f32 v29, v18, v19
    v_cvt_pk_bf16_f32 v30, v20, v21
    v_cvt_pk_bf16_f32 v31, v22, v23
    v_add_f32 v8, v16, v17
    v_add_f32 v9, v18, v19
    v_add_f32 v7, v20, v21
    v_add_f32 v8, v8, v9
    v_add_f32 v9, v22, v23
    v_add_f32 v7, v7, v9
    v_add_f32 v8, v8, v7
    v_fma_f32 v4, v4, v10, v8
    v_and_b32 v24, v5, v28
    v_and_b32 v28, v6, v28
    v_and_b32 v25, v5, v29
    v_and_b32 v29, v6, v29
    v_and_b32 v26, v5, v30
    v_and_b32 v30, v6, v30
    v_and_b32 v27, v5, v31
    v_and_b32 v31, v6, v31
    v_pk_mul_f32 v[176:177], v[176:177], v[44:45]
    v_pk_mul_f32 v[178:179], v[178:179], v[44:45]
    v_pk_mul_f32 v[180:181], v[180:181], v[44:45]
    v_pk_mul_f32 v[182:183], v[182:183], v[44:45]
    v_pk_mul_f32 v[184:185], v[184:185], v[44:45]
    v_pk_mul_f32 v[186:187], v[186:187], v[44:45]
    v_pk_mul_f32 v[188:189], v[188:189], v[44:45]
    v_pk_mul_f32 v[190:191], v[190:191], v[44:45]
    v_pk_mul_f32 v[192:193], v[192:193], v[44:45]
    v_pk_mul_f32 v[194:195], v[194:195], v[44:45]
    v_pk_mul_f32 v[196:197], v[196:197], v[44:45]
    v_pk_mul_f32 v[198:199], v[198:199], v[44:45]
    v_pk_mul_f32 v[200:201], v[200:201], v[44:45]
    v_pk_mul_f32 v[202:203], v[202:203], v[44:45]
    v_pk_mul_f32 v[204:205], v[204:205], v[44:45]
    v_pk_mul_f32 v[206:207], v[206:207], v[44:45]
    s_waitcnt vmcnt(48)
    v_perm_b32 v32, v52, v48, s55
    v_perm_b32 v33, v60, v56, s55
    v_perm_b32 v34, v68, v64, s55
    v_perm_b32 v35, v76, v72, s55
    v_perm_b32 v36, v52, v48, s56
    v_perm_b32 v37, v60, v56, s56
    v_perm_b32 v38, v68, v64, s56
    v_perm_b32 v39, v76, v72, s56
    v_mfma_f32_16x16x32_bf16 v[176:179], v[24:27], v[32:35], v[176:179]
    v_perm_b32 v40, v53, v49, s55
    v_perm_b32 v41, v61, v57, s55
    v_perm_b32 v42, v69, v65, s55
    v_perm_b32 v43, v77, v73, s55
    v_mfma_f32_16x16x32_bf16 v[180:183], v[24:27], v[36:39], v[180:183]
    v_perm_b32 v32, v53, v49, s56
    v_perm_b32 v33, v61, v57, s56
    v_perm_b32 v34, v69, v65, s56
    v_perm_b32 v35, v77, v73, s56
    v_mfma_f32_16x16x32_bf16 v[184:187], v[24:27], v[40:43], v[184:187]
    v_perm_b32 v36, v54, v50, s55
    v_perm_b32 v37, v62, v58, s55
    v_perm_b32 v38, v70, v66, s55
    v_perm_b32 v39, v78, v74, s55
    v_mfma_f32_16x16x32_bf16 v[188:191], v[24:27], v[32:35], v[188:191]
    v_perm_b32 v40, v54, v50, s56
    v_perm_b32 v41, v62, v58, s56
    v_perm_b32 v42, v70, v66, s56
    v_perm_b32 v43, v78, v74, s56
    v_mfma_f32_16x16x32_bf16 v[192:195], v[24:27], v[36:39], v[192:195]
    v_perm_b32 v32, v55, v51, s55
    v_perm_b32 v33, v63, v59, s55
    v_perm_b32 v34, v71, v67, s55
    v_perm_b32 v35, v79, v75, s55
    v_mfma_f32_16x16x32_bf16 v[196:199], v[24:27], v[40:43], v[196:199]
    v_perm_b32 v36, v55, v51, s56
    v_perm_b32 v37, v63, v59, s56
    v_perm_b32 v38, v71, v67, s56
    v_perm_b32 v39, v79, v75, s56
    v_mfma_f32_16x16x32_bf16 v[200:203], v[24:27], v[32:35], v[200:203]
    s_nop 1
    v_mfma_f32_16x16x32_bf16 v[204:207], v[24:27], v[36:39], v[204:207]
    v_perm_b32 v32, v84, v80, s55
    v_perm_b32 v33, v92, v88, s55
    v_perm_b32 v34, v100, v96, s55
    v_perm_b32 v35, v108, v104, s55
    v_perm_b32 v36, v84, v80, s56
    v_perm_b32 v37, v92, v88, s56
    v_perm_b32 v38, v100, v96, s56
    v_perm_b32 v39, v108, v104, s56
    v_mfma_f32_16x16x32_bf16 v[176:179], v[28:31], v[32:35], v[176:179]
    v_perm_b32 v40, v85, v81, s55
    v_perm_b32 v41, v93, v89, s55
    v_perm_b32 v42, v101, v97, s55
    v_perm_b32 v43, v109, v105, s55
    v_mfma_f32_16x16x32_bf16 v[180:183], v[28:31], v[36:39], v[180:183]
    v_perm_b32 v32, v85, v81, s56
    v_perm_b32 v33, v93, v89, s56
    v_perm_b32 v34, v101, v97, s56
    v_perm_b32 v35, v109, v105, s56
    v_mfma_f32_16x16x32_bf16 v[184:187], v[28:31], v[40:43], v[184:187]
    v_perm_b32 v36, v86, v82, s55
    v_perm_b32 v37, v94, v90, s55
    v_perm_b32 v38, v102, v98, s55
    v_perm_b32 v39, v110, v106, s55
    v_mfma_f32_16x16x32_bf16 v[188:191], v[28:31], v[32:35], v[188:191]
    v_perm_b32 v40, v86, v82, s56
    v_perm_b32 v41, v94, v90, s56
    v_perm_b32 v42, v102, v98, s56
    v_perm_b32 v43, v110, v106, s56
    v_mfma_f32_16x16x32_bf16 v[192:195], v[28:31], v[36:39], v[192:195]
    v_perm_b32 v32, v87, v83, s55
    v_perm_b32 v33, v95, v91, s55
    v_perm_b32 v34, v103, v99, s55
    v_perm_b32 v35, v111, v107, s55
    v_mfma_f32_16x16x32_bf16 v[196:199], v[28:31], v[40:43], v[196:199]
    v_perm_b32 v36, v87, v83, s56
    v_perm_b32 v37, v95, v91, s56
    v_perm_b32 v38, v103, v99, s56
    v_perm_b32 v39, v111, v107, s56
    v_mfma_f32_16x16x32_bf16 v[200:203], v[28:31], v[32:35], v[200:203]
    s_nop 1
    v_mfma_f32_16x16x32_bf16 v[204:207], v[28:31], v[36:39], v[204:207]
    s_add_u32 s60, s58, 8192
    buffer_load_dwordx4 v[48:51], v2, s[24:27], s58 offen offset:0 nt
    buffer_load_dwordx4 v[80:83], v2, s[24:27], s58 offen offset:256 nt
    buffer_load_dwordx4 v[52:55], v2, s[24:27], s58 offen offset:512 nt
    buffer_load_dwordx4 v[84:87], v2, s[24:27], s58 offen offset:768 nt
    buffer_load_dwordx4 v[56:59], v2, s[24:27], s58 offen offset:1024 nt
    buffer_load_dwordx4 v[88:91], v2, s[24:27], s58 offen offset:1280 nt
    buffer_load_dwordx4 v[60:63], v2, s[24:27], s58 offen offset:1536 nt
    buffer_load_dwordx4 v[92:95], v2, s[24:27], s58 offen offset:1792 nt
    buffer_load_dwordx4 v[64:67], v2, s[24:27], s60 offen offset:0 nt
    buffer_load_dwordx4 v[96:99], v2, s[24:27], s60 offen offset:256 nt
    buffer_load_dwordx4 v[68:71], v2, s[24:27], s60 offen offset:512 nt
    buffer_load_dwordx4 v[100:103], v2, s[24:27], s60 offen offset:768 nt
    buffer_load_dwordx4 v[72:75], v2, s[24:27], s60 offen offset:1024 nt
    buffer_load_dwordx4 v[104:107], v2, s[24:27], s60 offen offset:1280 nt
    buffer_load_dwordx4 v[76:79], v2, s[24:27], s60 offen offset:1536 nt
    buffer_load_dwordx4 v[108:111], v2, s[24:27], s60 offen offset:1792 nt
    s_add_u32 s58, s58, 16384
    s_cmp_lt_u32 s49, 61
    s_cbranch_scc1 NS_5
    s_waitcnt lgkmcnt(0)
    s_cmp_ge_u32 s50, 12
    s_cbranch_scc1 M_drain1
    s_and_b32 s70, s50, 3
    s_lshl_b32 s70, s70, 20
    s_lshr_b32 s71, s50, 2
    s_lshl_b32 s71, s71, 14
    s_add_u32 s57, s51, s70
    s_add_u32 s57, s57, s71
    s_mov_b32 s50, 1
    s_atomic_add s50, s[68:69], 0 glc
    s_branch NJ_6
NS_5:
    s_mov_b32 s57, s48
    s_add_u32 s48, s48, 16384
    s_add_u32 s49, s49, 1
    s_cmp_lg_u32 s49, 61
    s_cbranch_scc1 NJ_6
    s_mov_b32 s50, 1
    s_atomic_add s50, s[68:69], 0 glc
NJ_6:
    s_mov_b32 s58, s57
    s_waitcnt vmcnt(48)
    s_add_u32 s59, s57, 8192
    v_mfma_f32_16x16x32_bf16 v[16:19], a[64:67], a[128:131], 0
    buffer_load_dwordx4 a[64:67], v1, s[20:23], s57 offen offset:0 nt
    v_mfma_f32_16x16x32_bf16 v[16:19], a[68:71], a[132:135], v[16:19]
    buffer_load_dwordx4 a[68:71], v1, s[20:23], s57 offen offset:64 nt
    v_mfma_f32_16x16x32_bf16 v[16:19], a[72:75], a[136:139], v[16:19]
    buffer_load_dwordx4 a[72:75], v1, s[20:23], s57 offen offset:128 nt
    v_mfma_f32_16x16x32_bf16 v[16:19], a[76:79], a[140:143], v[16:19]
    buffer_load_dwordx4 a[76:79], v1, s[20:23], s57 offen offset:192 nt
    v_mfma_f32_16x16x32_bf16 v[16:19], a[80:83], a[144:147], v[16:19]
    buffer_load_dwordx4 a[80:83], v1, s[20:23], s57 offen offset:256 nt
    v_mfma_f32_16x16x32_bf16 v[16:19], a[84:87], a[148:151], v[16:19]
    buffer_load_dwordx4 a[84:87], v1, s[20:23], s57 offen offset:320 nt
    v_mfma_f32_16x16x32_bf16 v[16:19], a[88:91], a[152:155], v[16:19]
    buffer_load_dwordx4 a[88:91], v1, s[20:23], s57 offen offset:384 nt
    v_mfma_f32_16x16x32_bf16 v[16:19], a[92:95], a[156:159], v[16:19]
    buffer_load_dwordx4 a[92:95], v1, s[20:23], s57 offen offset:448 nt
    v_mfma_f32_16x16x32_bf16 v[20:23], a[96:99], a[128:131], 0
    buffer_load_dwordx4 a[96:99], v1, s[20:23], s59 offen offset:0 nt
    v_mfma_f32_16x16x32_bf16 v[20:23], a[100:103], a[132:135], v[20:23]
    buffer_load_dwordx4 a[100:103], v1, s[20:23], s59 offen offset:64 nt
    v_mfma_f32_16x16x32_bf16 v[20:23], a[104:107], a[136:139], v[20:23]
    buffer_load_dwordx4 a[104:107], v1, s[20:23], s59 offen offset:128 nt
    v_mfma_f32_16x16x32_bf16 v[20:23], a[108:111], a[140:143], v[20:23]
    buffer_load_dwordx4 a[108:111], v1, s[20:23], s59 offen offset:192 nt
    v_mfma_f32_16x16x32_bf16 v[20:23], a[112:115], a[144:147], v[20:23]
    buffer_load_dwordx4 a[112:115], v1, s[20:23], s59 offen offset:256 nt
    v_mfma_f32_16x16x32_bf16 v[20:23], a[116:119], a[148:151], v[20:23]
    buffer_load_dwordx4 a[116:119], v1, s[20:23], s59 offen offset:320 nt
    v_mfma_f32_16x16x32_bf16 v[20:23], a[120:123], a[152:155], v[20:23]
    buffer_load_dwordx4 a[120:123], v1, s[20:23], s59 offen offset:384 nt
    v_mfma_f32_16x16x32_bf16 v[20:23], a[124:127], a[156:159], v[20:23]
    buffer_load_dwordx4 a[124:127], v1, s[20:23], s59 offen offset:448 nt
    s_add_u32 s57, s57, 16384
    s_nop 5
    v_cvt_pk_bf16_f32 v24, v16, v17
    v_cvt_pk_bf16_f32 v25, v18, v19
    v_cvt_pk_bf16_f32 v26, v20, v21
    v_cvt_pk_bf16_f32 v27, v22, v23
    v_lshlrev_b32 v16, 16, v24
    v_and_b32 v17, 0xffff0000, v24
    v_lshlrev_b32 v18, 16, v25
    v_and_b32 v19, 0xffff0000, v25
    v_lshlrev_b32 v20, 16, v26
    v_and_b32 v21, 0xffff0000, v26
    v_lshlrev_b32 v22, 16, v27
    v_and_b32 v23, 0xffff0000, v27
    v_max3_f32 v7, v16, v17, v18
    v_max3_f32 v7, v7, v19, v20
    v_max3_f32 v7, v7, v21, v22
    v_max_f32 v7, v7, v23
    v_mov_b32 v8, v7
    s_nop 1
    v_permlane16_swap_b32 v7, v8
    s_nop 0
    v_max_f32 v7, v7, v8
    v_mov_b32 v8, v7
    s_nop 1
    v_permlane32_swap_b32 v7, v8
    s_nop 0
    v_max_f32 v7, v7, v8
    v_mul_f32 v7, s54, v7
    v_max_f32 v7, v3, v7
    v_sub_f32 v8, v3, v7
    v_exp_f32 v10, v8
    v_mov_b32 v3, v7
    v_fma_f32 v16, v16, s54, -v7
    v_fma_f32 v17, v17, s54, -v7
    v_fma_f32 v18, v18, s54, -v7
    v_fma_f32 v19, v19, s54, -v7
    v_fma_f32 v20, v20, s54, -v7
    v_fma_f32 v21, v21, s54, -v7
    v_fma_f32 v22, v22, s54, -v7
    v_fma_f32 v23, v23, s54, -v7
    v_exp_f32 v16, v16
    v_exp_f32 v17, v17
    v_exp_f32 v18, v18
    v_exp_f32 v19, v19
    v_exp_f32 v20, v20
    v_exp_f32 v21, v21
    v_exp_f32 v22, v22
    v_exp_f32 v23, v23
    v_mov_b32_dpp v44, v10 quad_perm:[0,0,2,2] row_mask:0xf bank_mask:0xf
    v_mov_b32_dpp v45, v10 quad_perm:[1,1,3,3] row_mask:0xf bank_mask:0xf
    v_cvt_pk_bf16_f32 v28, v16, v17
    v_cvt_pk_bf16_f32 v29, v18, v19
    v_cvt_pk_bf16_f32 v30, v20, v21
    v_cvt_pk_bf16_f32 v31, v22, v23
    v_add_f32 v8, v16, v17
    v_add_f32 v9, v18, v19
    v_add_f32 v7, v20, v21
    v_add_f32 v8, v8, v9
    v_add_f32 v9, v22, v23
    v_add_f32 v7, v7, v9
    v_add_f32 v8, v8, v7
    v_fma_f32 v4, v4, v10, v8
    v_and_b32 v24, v5, v28
    v_and_b32 v28, v6, v28
    v_and_b32 v25, v5, v29
    v_and_b32 v29, v6, v29
    v_and_b32 v26, v5, v30
    v_and_b32 v30, v6, v30
    v_and_b32 v27, v5, v31
    v_and_b32 v31, v6, v31
    v_pk_mul_f32 v[176:177], v[176:177], v[44:45]
    v_pk_mul_f32 v[178:179], v[178:179], v[44:45]
    v_pk_mul_f32 v[180:181], v[180:181], v[44:45]
    v_pk_mul_f32 v[182:183], v[182:183], v[44:45]
    v_pk_mul_f32 v[184:185], v[184:185], v[44:45]
    v_pk_mul_f32 v[186:187], v[186:187], v[44:45]
    v_pk_mul_f32 v[188:189], v[188:189], v[44:45]
    v_pk_mul_f32 v[190:191], v[190:191], v[44:45]
    v_pk_mul_f32 v[192:193], v[192:193], v[44:45]
    v_pk_mul_f32 v[194:195], v[194:195], v[44:45]
    v_pk_mul_f32 v[196:197], v[196:197], v[44:45]
    v_pk_mul_f32 v[198:199], v[198:199], v[44:45]
    v_pk_mul_f32 v[200:201], v[200:201], v[44:45]
    v_pk_mul_f32 v[202:203], v[202:203], v[44:45]
    v_pk_mul_f32 v[204:205], v[204:205], v[44:45]
    v_pk_mul_f32 v[206:207], v[206:207], v[44:45]
    s_waitcnt vmcnt(48)
    v_perm_b32 v32, v116, v112, s55
    v_perm_b32 v33, v124, v120, s55
    v_perm_b32 v34, v132, v128, s55
    v_perm_b32 v35, v140, v136, s55
    v_perm_b32 v36, v116, v112, s56
    v_perm_b32 v37, v124, v120, s56
    v_perm_b32 v38, v132, v128, s56
    v_perm_b32 v39, v140, v136, s56
    v_mfma_f32_16x16x32_bf16 v[176:179], v[24:27], v[32:35], v[176:179]
    v_perm_b32 v40, v117, v113, s55
    v_perm_b32 v41, v125, v121, s55
    v_perm_b32 v42, v133, v129, s55
    v_perm_b32 v43, v141, v137, s55
    v_mfma_f32_16x16x32_bf16 v[180:183], v[24:27], v[36:39], v[180:183]
    v_perm_b32 v32, v117, v113, s56
    v_perm_b32 v33, v125, v121, s56
    v_perm_b32 v34, v133, v129, s56
    v_perm_b32 v35, v141, v137, s56
    v_mfma_f32_16x16x32_bf16 v[184:187], v[24:27], v[40:43], v[184:187]
    v_perm_b32 v36, v118, v114, s55
    v_perm_b32 v37, v126, v122, s55
    v_perm_b32 v38, v134, v130, s55
    v_perm_b32 v39, v142, v138, s55
    v_mfma_f32_16x16x32_bf16 v[188:191], v[24:27], v[32:35], v[188:191]
    v_perm_b32 v40, v118, v114, s56
    v_perm_b32 v41, v126, v122, s56
    v_perm_b32 v42, v134, v130, s56
    v_perm_b32 v43, v142, v138, s56
    v_mfma_f32_16x16x32_bf16 v[192:195], v[24:27], v[36:39], v[192:195]
    v_perm_b32 v32, v119, v115, s55
    v_perm_b32 v33, v127, v123, s55
    v_perm_b32 v34, v135, v131, s55
    v_perm_b32 v35, v143, v139, s55
    v_mfma_f32_16x16x32_bf16 v[196:199], v[24:27], v[40:43], v[196:199]
    v_perm_b32 v36, v119, v115, s56
    v_perm_b32 v37, v127, v123, s56
    v_perm_b32 v38, v135, v131, s56
    v_perm_b32 v39, v143, v139, s56
    v_mfma_f32_16x16x32_bf16 v[200:203], v[24:27], v[32:35], v[200:203]
    s_nop 1
    v_mfma_f32_16x16x32_bf16 v[204:207], v[24:27], v[36:39], v[204:207]
    v_perm_b32 v32, v148, v144, s55
    v_perm_b32 v33, v156, v152, s55
    v_perm_b32 v34, v164, v160, s55
    v_perm_b32 v35, v172, v168, s55
    v_perm_b32 v36, v148, v144, s56
    v_perm_b32 v37, v156, v152, s56
    v_perm_b32 v38, v164, v160, s56
    v_perm_b32 v39, v172, v168, s56
    v_mfma_f32_16x16x32_bf16 v[176:179], v[28:31], v[32:35], v[176:179]
    v_perm_b32 v40, v149, v145, s55
    v_perm_b32 v41, v157, v153, s55
    v_perm_b32 v42, v165, v161, s55
    v_perm_b32 v43, v173, v169, s55
    v_mfma_f32_16x16x32_bf16 v[180:183], v[28:31], v[36:39], v[180:183]
    v_perm_b32 v32, v149, v145, s56
    v_perm_b32 v33, v157, v153, s56
    v_perm_b32 v34, v165, v161, s56
    v_perm_b32 v35, v173, v169, s56
    v_mfma_f32_16x16x32_bf16 v[184:187], v[28:31], v[40:43], v[184:187]
    v_perm_b32 v36, v150, v146, s55
    v_perm_b32 v37, v158, v154, s55
    v_perm_b32 v38, v166, v162, s55
    v_perm_b32 v39, v174, v170, s55
    v_mfma_f32_16x16x32_bf16 v[188:191], v[28:31], v[32:35], v[188:191]
    v_perm_b32 v40, v150, v146, s56
    v_perm_b32 v41, v158, v154, s56
    v_perm_b32 v42, v166, v162, s56
    v_perm_b32 v43, v174, v170, s56
    v_mfma_f32_16x16x32_bf16 v[192:195], v[28:31], v[36:39], v[192:195]
    v_perm_b32 v32, v151, v147, s55
    v_perm_b32 v33, v159, v155, s55
    v_perm_b32 v34, v167, v163, s55
    v_perm_b32 v35, v175, v171, s55
    v_mfma_f32_16x16x32_bf16 v[196:199], v[28:31], v[40:43], v[196:199]
    v_perm_b32 v36, v151, v147, s56
    v_perm_b32 v37, v159, v155, s56
    v_perm_b32 v38, v167, v163, s56
    v_perm_b32 v39, v175, v171, s56
    v_mfma_f32_16x16x32_bf16 v[200:203], v[28:31], v[32:35], v[200:203]
    s_nop 1
    v_mfma_f32_16x16x32_bf16 v[204:207], v[28:31], v[36:39], v[204:207]
    s_add_u32 s60, s58, 8192
    buffer_load_dwordx4 v[112:115], v2, s[24:27], s58 offen offset:0 nt
    buffer_load_dwordx4 v[144:147], v2, s[24:27], s58 offen offset:256 nt
    buffer_load_dwordx4 v[116:119], v2, s[24:27], s58 offen offset:512 nt
    buffer_load_dwordx4 v[148:151], v2, s[24:27], s58 offen offset:768 nt
    buffer_load_dwordx4 v[120:123], v2, s[24:27], s58 offen offset:1024 nt
    buffer_load_dwordx4 v[152:155], v2, s[24:27], s58 offen offset:1280 nt
    buffer_load_dwordx4 v[124:127], v2, s[24:27], s58 offen offset:1536 nt
    buffer_load_dwordx4 v[156:159], v2, s[24:27], s58 offen offset:1792 nt
    buffer_load_dwordx4 v[128:131], v2, s[24:27], s60 offen offset:0 nt
    buffer_load_dwordx4 v[160:163], v2, s[24:27], s60 offen offset:256 nt
    buffer_load_dwordx4 v[132:135], v2, s[24:27], s60 offen offset:512 nt
    buffer_load_dwordx4 v[164:167], v2, s[24:27], s60 offen offset:768 nt
    buffer_load_dwordx4 v[136:139], v2, s[24:27], s60 offen offset:1024 nt
    buffer_load_dwordx4 v[168:171], v2, s[24:27], s60 offen offset:1280 nt
    buffer_load_dwordx4 v[140:143], v2, s[24:27], s60 offen offset:1536 nt
    buffer_load_dwordx4 v[172:175], v2, s[24:27], s60 offen offset:1792 nt
    s_add_u32 s58, s58, 16384
    s_branch M_loop
M_merge:
    v_mov_b32 v8, 25856
    s_mov_b32 s75, 2097152
W_7:
    ds_read_b128 v[32:35], v8 offset:16
    s_sub_u32 s75, s75, 1
    s_cmp_eq_u32 s75, 0
    s_cbranch_scc1 M_end
    s_waitcnt lgkmcnt(0)
    v_readfirstlane_b32 s79, v35
    s_nop 0
    s_cmp_lg_u32 s79, 0
    s_cbranch_scc1 K_8
    s_sleep 1
    s_branch W_7
K_8:
    s_mov_b32 s63, s79
    v_mov_b32 v8, 25856
    s_mov_b32 s75, 2097152
W_9:
    ds_read_b128 v[32:35], v8 offset:0
    s_sub_u32 s75, s75, 1
    s_cmp_eq_u32 s75, 0
    s_cbranch_scc1 M_end
    s_waitcnt lgkmcnt(0)
    v_readfirstlane_b32 s79, v35
    s_nop 0
    s_cmp_lg_u32 s79, 0
    s_cbranch_scc1 K_10
    s_sleep 1
    s_branch W_9
K_10:
    v_lshlrev_b32 v11, 4, v0
    ds_read_b128 v[32:35], v11 offset:22528
    s_waitcnt lgkmcnt(0)
    v_max_f32 v7, v3, v32
    v_sub_f32 v8, v3, v7
    v_sub_f32 v9, v32, v7
    v_exp_f32 v8, v8
    v_exp_f32 v9, v9
    v_mov_b32 v3, v7
    s_nop 0
    v_mul_f32 v4, v4, v8
    v_fmac_f32 v4, v33, v9
    v_mov_b32_dpp v44, v8 quad_perm:[0,0,2,2] row_mask:0xf bank_mask:0xf
    v_mov_b32_dpp v45, v8 quad_perm:[1,1,3,3] row_mask:0xf bank_mask:0xf
    v_mov_b32_dpp v12, v9 quad_perm:[0,0,2,2] row_mask:0xf bank_mask:0xf
    v_mov_b32_dpp v13, v9 quad_perm:[1,1,3,3] row_mask:0xf bank_mask:0xf
    ds_read_b128 v[16:19], v11 offset:14336
    ds_read_b128 v[20:23], v11 offset:15360
    ds_read_b128 v[24:27], v11 offset:16384
    ds_read_b128 v[28:31], v11 offset:17408
    v_pk_mul_f32 v[176:177], v[176:177], v[44:45]
    v_pk_mul_f32 v[178:179], v[178:179], v[44:45]
    v_pk_mul_f32 v[180:181], v[180:181], v[44:45]
    v_pk_mul_f32 v[182:183], v[182:183], v[44:45]
    v_pk_mul_f32 v[184:185], v[184:185], v[44:45]
    v_pk_mul_f32 v[186:187], v[186:187], v[44:45]
    v_pk_mul_f32 v[188:189], v[188:189], v[44:45]
    v_pk_mul_f32 v[190:191], v[190:191], v[44:45]
    s_waitcnt lgkmcnt(0)
    v_pk_fma_f32 v[176:177], v[16:17], v[12:13], v[176:177]
    v_pk_fma_f32 v[178:179], v[18:19], v[12:13], v[178:179]
    v_pk_fma_f32 v[180:181], v[20:21], v[12:13], v[180:181]
    v_pk_fma_f32 v[182:183], v[22:23], v[12:13], v[182:183]
    v_pk_fma_f32 v[184:185], v[24:25], v[12:13], v[184:185]
    v_pk_fma_f32 v[186:187], v[26:27], v[12:13], v[186:187]
    v_pk_fma_f32 v[188:189], v[28:29], v[12:13], v[188:189]
    v_pk_fma_f32 v[190:191], v[30:31], v[12:13], v[190:191]
    ds_read_b128 v[16:19], v11 offset:18432
    ds_read_b128 v[20:23], v11 offset:19456
    ds_read_b128 v[24:27], v11 offset:20480
    ds_read_b128 v[28:31], v11 offset:21504
    v_pk_mul_f32 v[192:193], v[192:193], v[44:45]
    v_pk_mul_f32 v[194:195], v[194:195], v[44:45]
    v_pk_mul_f32 v[196:197], v[196:197], v[44:45]
    v_pk_mul_f32 v[198:199], v[198:199], v[44:45]
    v_pk_mul_f32 v[200:201], v[200:201], v[44:45]
    v_pk_mul_f32 v[202:203], v[202:203], v[44:45]
    v_pk_mul_f32 v[204:205], v[204:205], v[44:45]
    v_pk_mul_f32 v[206:207], v[206:207], v[44:45]
    s_waitcnt lgkmcnt(0)
    v_pk_fma_f32 v[192:193], v[16:17], v[12:13], v[192:193]
    v_pk_fma_f32 v[194:195], v[18:19], v[12:13], v[194:195]
    v_pk_fma_f32 v[196:197], v[20:21], v[12:13], v[196:197]
    v_pk_fma_f32 v[198:199], v[22:23], v[12:13], v[198:199]
    v_pk_fma_f32 v[200:201], v[24:25], v[12:13], v[200:201]
    v_pk_fma_f32 v[202:203], v[26:27], v[12:13], v[202:203]
    v_pk_fma_f32 v[204:205], v[28:29], v[12:13], v[204:205]
    v_pk_fma_f32 v[206:207], v[30:31], v[12:13], v[206:207]
    s_branch M_merged
M_drain1:
    s_barrier
    s_lshl_b32 s70, s2, 12
    s_add_u32 s70, s70, 262144
    s_lshl_b32 s72, s2, 7
    s_add_u32 s72, s72, 1310720
    s_waitcnt vmcnt(48)
    v_mfma_f32_16x16x32_bf16 v[16:19], a[64:67], a[128:131], 0
    v_mfma_f32_16x16x32_bf16 v[16:19], a[68:71], a[132:135], v[16:19]
    v_mfma_f32_16x16x32_bf16 v[16:19], a[72:75], a[136:139], v[16:19]
    v_mfma_f32_16x16x32_bf16 v[16:19], a[76:79], a[140:143], v[16:19]
    v_mfma_f32_16x16x32_bf16 v[16:19], a[80:83], a[144:147], v[16:19]
    v_mfma_f32_16x16x32_bf16 v[16:19], a[84:87], a[148:151], v[16:19]
    v_mfma_f32_16x16x32_bf16 v[16:19], a[88:91], a[152:155], v[16:19]
    v_mfma_f32_16x16x32_bf16 v[16:19], a[92:95], a[156:159], v[16:19]
    v_mfma_f32_16x16x32_bf16 v[20:23], a[96:99], a[128:131], 0
    v_mfma_f32_16x16x32_bf16 v[20:23], a[100:103], a[132:135], v[20:23]
    v_mfma_f32_16x16x32_bf16 v[20:23], a[104:107], a[136:139], v[20:23]
    v_mfma_f32_16x16x32_bf16 v[20:23], a[108:111], a[140:143], v[20:23]
    v_mfma_f32_16x16x32_bf16 v[20:23], a[112:115], a[144:147], v[20:23]
    v_mfma_f32_16x16x32_bf16 v[20:23], a[116:119], a[148:151], v[20:23]
    v_mfma_f32_16x16x32_bf16 v[20:23], a[120:123], a[152:155], v[20:23]
    v_mfma_f32_16x16x32_bf16 v[20:23], a[124:127], a[156:159], v[20:23]
    s_nop 6
    v_cvt_pk_bf16_f32 v24, v16, v17
    v_cvt_pk_bf16_f32 v25, v18, v19
    v_cvt_pk_bf16_f32 v26, v20, v21
    v_cvt_pk_bf16_f32 v27, v22, v23
    v_lshlrev_b32 v16, 16, v24
    v_and_b32 v17, 0xffff0000, v24
    v_lshlrev_b32 v18, 16, v25
    v_and_b32 v19, 0xffff0000, v25
    v_lshlrev_b32 v20, 16, v26
    v_and_b32 v21, 0xffff0000, v26
    v_lshlrev_b32 v22, 16, v27
    v_and_b32 v23, 0xffff0000, v27
    v_max3_f32 v7, v16, v17, v18
    v_max3_f32 v7, v7, v19, v20
    v_max3_f32 v7, v7, v21, v22
    v_max_f32 v7, v7, v23
    v_mov_b32 v8, v7
    s_nop 1
    v_permlane16_swap_b32 v7, v8
    s_nop 0
    v_max_f32 v7, v7, v8
    v_mov_b32 v8, v7
    s_nop 1
    v_permlane32_swap_b32 v7, v8
    s_nop 0
    v_max_f32 v7, v7, v8
    v_mul_f32 v7, s54, v7
    v_max_f32 v7, v3, v7
    v_sub_f32 v8, v3, v7
    v_exp_f32 v10, v8
    v_mov_b32 v3, v7
    v_fma_f32 v16, v16, s54, -v7
    v_fma_f32 v17, v17, s54, -v7
    v_fma_f32 v18, v18, s54, -v7
    v_fma_f32 v19, v19, s54, -v7
    v_fma_f32 v20, v20, s54, -v7
    v_fma_f32 v21, v21, s54, -v7
    v_fma_f32 v22, v22, s54, -v7
    v_fma_f32 v23, v23, s54, -v7
    v_exp_f32 v16, v16
    v_exp_f32 v17, v17
    v_exp_f32 v18, v18
    v_exp_f32 v19, v19
    v_exp_f32 v20, v20
    v_exp_f32 v21, v21
    v_exp_f32 v22, v22
    v_exp_f32 v23, v23
    v_mov_b32_dpp v44, v10 quad_perm:[0,0,2,2] row_mask:0xf bank_mask:0xf
    v_mov_b32_dpp v45, v10 quad_perm:[1,1,3,3] row_mask:0xf bank_mask:0xf
    v_cvt_pk_bf16_f32 v28, v16, v17
    v_cvt_pk_bf16_f32 v29, v18, v19
    v_cvt_pk_bf16_f32 v30, v20, v21
    v_cvt_pk_bf16_f32 v31, v22, v23
    v_add_f32 v8, v16, v17
    v_add_f32 v9, v18, v19
    v_add_f32 v7, v20, v21
    v_add_f32 v8, v8, v9
    v_add_f32 v9, v22, v23
    v_add_f32 v7, v7, v9
    v_add_f32 v8, v8, v7
    v_fma_f32 v4, v4, v10, v8
    v_and_b32 v24, v5, v28
    v_and_b32 v28, v6, v28
    v_and_b32 v25, v5, v29
    v_and_b32 v29, v6, v29
    v_and_b32 v26, v5, v30
    v_and_b32 v30, v6, v30
    v_and_b32 v27, v5, v31
    v_and_b32 v31, v6, v31
    v_pk_mul_f32 v[176:177], v[176:177], v[44:45]
    v_pk_mul_f32 v[178:179], v[178:179], v[44:45]
    v_pk_mul_f32 v[180:181], v[180:181], v[44:45]
    v_pk_mul_f32 v[182:183], v[182:183], v[44:45]
    v_pk_mul_f32 v[184:185], v[184:185], v[44:45]
    v_pk_mul_f32 v[186:187], v[186:187], v[44:45]
    v_pk_mul_f32 v[188:189], v[188:189], v[44:45]
    v_pk_mul_f32 v[190:191], v[190:191], v[44:45]
    v_pk_mul_f32 v[192:193], v[192:193], v[44:45]
    v_pk_mul_f32 v[194:195], v[194:195], v[44:45]
    v_pk_mul_f32 v[196:197], v[196:197], v[44:45]
    v_pk_mul_f32 v[198:199], v[198:199], v[44:45]
    v_pk_mul_f32 v[200:201], v[200:201], v[44:45]
    v_pk_mul_f32 v[202:203], v[202:203], v[44:45]
    v_pk_mul_f32 v[204:205], v[204:205], v[44:45]
    v_pk_mul_f32 v[206:207], v[206:207], v[44:45]
    s_waitcnt vmcnt(32)
    v_perm_b32 v32, v116, v112, s55
    v_perm_b32 v33, v124, v120, s55
    v_perm_b32 v34, v132, v128, s55
    v_perm_b32 v35, v140, v136, s55
    v_perm_b32 v36, v116, v112, s56
    v_perm_b32 v37, v124, v120, s56
    v_perm_b32 v38, v132, v128, s56
    v_perm_b32 v39, v140, v136, s56
    v_mfma_f32_16x16x32_bf16 v[176:179], v[24:27], v[32:35], v[176:179]
    v_perm_b32 v40, v117, v113, s55
    v_perm_b32 v41, v125, v121, s55
    v_perm_b32 v42, v133, v129, s55
    v_perm_b32 v43, v141, v137, s55
    v_mfma_f32_16x16x32_bf16 v[180:183], v[24:27], v[36:39], v[180:183]
    v_perm_b32 v32, v117, v113, s56
    v_perm_b32 v33, v125, v121, s56
    v_perm_b32 v34, v133, v129, s56
    v_perm_b32 v35, v141, v137, s56
    v_mfma_f32_16x16x32_bf16 v[184:187], v[24:27], v[40:43], v[184:187]
    v_perm_b32 v36, v118, v114, s55
    v_perm_b32 v37, v126, v122, s55
    v_perm_b32 v38, v134, v130, s55
    v_perm_b32 v39, v142, v138, s55
    v_mfma_f32_16x16x32_bf16 v[188:191], v[24:27], v[32:35], v[188:191]
    v_perm_b32 v40, v118, v114, s56
    v_perm_b32 v41, v126, v122, s56
    v_perm_b32 v42, v134, v130, s56
    v_perm_b32 v43, v142, v138, s56
    v_mfma_f32_16x16x32_bf16 v[192:195], v[24:27], v[36:39], v[192:195]
    v_perm_b32 v32, v119, v115, s55
    v_perm_b32 v33, v127, v123, s55
    v_perm_b32 v34, v135, v131, s55
    v_perm_b32 v35, v143, v139, s55
    v_mfma_f32_16x16x32_bf16 v[196:199], v[24:27], v[40:43], v[196:199]
    v_perm_b32 v36, v119, v115, s56
    v_perm_b32 v37, v127, v123, s56
    v_perm_b32 v38, v135, v131, s56
    v_perm_b32 v39, v143, v139, s56
    v_mfma_f32_16x16x32_bf16 v[200:203], v[24:27], v[32:35], v[200:203]
    s_nop 1
    v_mfma_f32_16x16x32_bf16 v[204:207], v[24:27], v[36:39], v[204:207]
    v_perm_b32 v32, v148, v144, s55
    v_perm_b32 v33, v156, v152, s55
    v_perm_b32 v34, v164, v160, s55
    v_perm_b32 v35, v172, v168, s55
    v_perm_b32 v36, v148, v144, s56
    v_perm_b32 v37, v156, v152, s56
    v_perm_b32 v38, v164, v160, s56
    v_perm_b32 v39, v172, v168, s56
    v_mfma_f32_16x16x32_bf16 v[176:179], v[28:31], v[32:35], v[176:179]
    v_perm_b32 v40, v149, v145, s55
    v_perm_b32 v41, v157, v153, s55
    v_perm_b32 v42, v165, v161, s55
    v_perm_b32 v43, v173, v169, s55
    v_mfma_f32_16x16x32_bf16 v[180:183], v[28:31], v[36:39], v[180:183]
    v_perm_b32 v32, v149, v145, s56
    v_perm_b32 v33, v157, v153, s56
    v_perm_b32 v34, v165, v161, s56
    v_perm_b32 v35, v173, v169, s56
    v_mfma_f32_16x16x32_bf16 v[184:187], v[28:31], v[40:43], v[184:187]
    v_perm_b32 v36, v150, v146, s55
    v_perm_b32 v37, v158, v154, s55
    v_perm_b32 v38, v166, v162, s55
    v_perm_b32 v39, v174, v170, s55
    v_mfma_f32_16x16x32_bf16 v[188:191], v[28:31], v[32:35], v[188:191]
    v_perm_b32 v40, v150, v146, s56
    v_perm_b32 v41, v158, v154, s56
    v_perm_b32 v42, v166, v162, s56
    v_perm_b32 v43, v174, v170, s56
    v_mfma_f32_16x16x32_bf16 v[192:195], v[28:31], v[36:39], v[192:195]
    v_perm_b32 v32, v151, v147, s55
    v_perm_b32 v33, v159, v155, s55
    v_perm_b32 v34, v167, v163, s55
    v_perm_b32 v35, v175, v171, s55
    v_mfma_f32_16x16x32_bf16 v[196:199], v[28:31], v[40:43], v[196:199]
    v_perm_b32 v36, v151, v147, s56
    v_perm_b32 v37, v159, v155, s56
    v_perm_b32 v38, v167, v163, s56
    v_perm_b32 v39, v175, v171, s56
    v_mfma_f32_16x16x32_bf16 v[200:203], v[28:31], v[32:35], v[200:203]
    s_nop 1
    v_mfma_f32_16x16x32_bf16 v[204:207], v[28:31], v[36:39], v[204:207]
    s_waitcnt vmcnt(16)
    v_mfma_f32_16x16x32_bf16 v[16:19], a[0:3], a[128:131], 0
    v_mfma_f32_16x16x32_bf16 v[16:19], a[4:7], a[132:135], v[16:19]
    v_mfma_f32_16x16x32_bf16 v[16:19], a[8:11], a[136:139], v[16:19]
    v_mfma_f32_16x16x32_bf16 v[16:19], a[12:15], a[140:143], v[16:19]
    v_mfma_f32_16x16x32_bf16 v[16:19], a[16:19], a[144:147], v[16:19]
    v_mfma_f32_16x16x32_bf16 v[16:19], a[20:23], a[148:151], v[16:19]
    v_mfma_f32_16x16x32_bf16 v[16:19], a[24:27], a[152:155], v[16:19]
    v_mfma_f32_16x16x32_bf16 v[16:19], a[28:31], a[156:159], v[16:19]
    v_mfma_f32_16x16x32_bf16 v[20:23], a[32:35], a[128:131], 0
    v_mfma_f32_16x16x32_bf16 v[20:23], a[36:39], a[132:135], v[20:23]
    v_mfma_f32_16x16x32_bf16 v[20:23], a[40:43], a[136:139], v[20:23]
    v_mfma_f32_16x16x32_bf16 v[20:23], a[44:47], a[140:143], v[20:23]
    v_mfma_f32_16x16x32_bf16 v[20:23], a[48:51], a[144:147], v[20:23]
    v_mfma_f32_16x16x32_bf16 v[20:23], a[52:55], a[148:151], v[20:23]
    v_mfma_f32_16x16x32_bf16 v[20:23], a[56:59], a[152:155], v[20:23]
    v_mfma_f32_16x16x32_bf16 v[20:23], a[60:63], a[156:159], v[20:23]
    s_nop 6
    v_cvt_pk_bf16_f32 v24, v16, v17
    v_cvt_pk_bf16_f32 v25, v18, v19
    v_cvt_pk_bf16_f32 v26, v20, v21
    v_cvt_pk_bf16_f32 v27, v22, v23
    v_lshlrev_b32 v16, 16, v24
    v_and_b32 v17, 0xffff0000, v24
    v_lshlrev_b32 v18, 16, v25
    v_and_b32 v19, 0xffff0000, v25
    v_lshlrev_b32 v20, 16, v26
    v_and_b32 v21, 0xffff0000, v26
    v_lshlrev_b32 v22, 16, v27
    v_and_b32 v23, 0xffff0000, v27
    v_max3_f32 v7, v16, v17, v18
    v_max3_f32 v7, v7, v19, v20
    v_max3_f32 v7, v7, v21, v22
    v_max_f32 v7, v7, v23
    v_mov_b32 v8, v7
    s_nop 1
    v_permlane16_swap_b32 v7, v8
    s_nop 0
    v_max_f32 v7, v7, v8
    v_mov_b32 v8, v7
    s_nop 1
    v_permlane32_swap_b32 v7, v8
    s_nop 0
    v_max_f32 v7, v7, v8
    v_mul_f32 v7, s54, v7
    v_max_f32 v7, v3, v7
    v_sub_f32 v8, v3, v7
    v_exp_f32 v10, v8
    v_mov_b32 v3, v7
    v_fma_f32 v16, v16, s54, -v7
    v_fma_f32 v17, v17, s54, -v7
    v_fma_f32 v18, v18, s54, -v7
    v_fma_f32 v19, v19, s54, -v7
    v_fma_f32 v20, v20, s54, -v7
    v_fma_f32 v21, v21, s54, -v7
    v_fma_f32 v22, v22, s54, -v7
    v_fma_f32 v23, v23, s54, -v7
    v_exp_f32 v16, v16
    v_exp_f32 v17, v17
    v_exp_f32 v18, v18
    v_exp_f32 v19, v19
    v_exp_f32 v20, v20
    v_exp_f32 v21, v21
    v_exp_f32 v22, v22
    v_exp_f32 v23, v23
    v_mov_b32_dpp v44, v10 quad_perm:[0,0,2,2] row_mask:0xf bank_mask:0xf
    v_mov_b32_dpp v45, v10 quad_perm:[1,1,3,3] row_mask:0xf bank_mask:0xf
    v_cvt_pk_bf16_f32 v28, v16, v17
    v_cvt_pk_bf16_f32 v29, v18, v19
    v_cvt_pk_bf16_f32 v30, v20, v21
    v_cvt_pk_bf16_f32 v31, v22, v23
    v_add_f32 v8, v16, v17
    v_add_f32 v9, v18, v19
    v_add_f32 v7, v20, v21
    v_add_f32 v8, v8, v9
    v_add_f32 v9, v22, v23
    v_add_f32 v7, v7, v9
    v_add_f32 v8, v8, v7
    v_fma_f32 v4, v4, v10, v8
    v_and_b32 v24, v5, v28
    v_and_b32 v28, v6, v28
    v_and_b32 v25, v5, v29
    v_and_b32 v29, v6, v29
    v_and_b32 v26, v5, v30
    v_and_b32 v30, v6, v30
    v_and_b32 v27, v5, v31
    v_and_b32 v31, v6, v31
    v_pk_mul_f32 v[176:177], v[176:177], v[44:45]
    v_pk_mul_f32 v[178:179], v[178:179], v[44:45]
    v_pk_mul_f32 v[180:181], v[180:181], v[44:45]
    v_pk_mul_f32 v[182:183], v[182:183], v[44:45]
    v_pk_mul_f32 v[184:185], v[184:185], v[44:45]
    v_pk_mul_f32 v[186:187], v[186:187], v[44:45]
    v_pk_mul_f32 v[188:189], v[188:189], v[44:45]
    v_pk_mul_f32 v[190:191], v[190:191], v[44:45]
    v_pk_mul_f32 v[192:193], v[192:193], v[44:45]
    v_pk_mul_f32 v[194:195], v[194:195], v[44:45]
    v_pk_mul_f32 v[196:197], v[196:197], v[44:45]
    v_pk_mul_f32 v[198:199], v[198:199], v[44:45]
    v_pk_mul_f32 v[200:201], v[200:201], v[44:45]
    v_pk_mul_f32 v[202:203], v[202:203], v[44:45]
    v_pk_mul_f32 v[204:205], v[204:205], v[44:45]
    v_pk_mul_f32 v[206:207], v[206:207], v[44:45]
    s_waitcnt vmcnt(0)
    v_perm_b32 v32, v52, v48, s55
    v_perm_b32 v33, v60, v56, s55
    v_perm_b32 v34, v68, v64, s55
    v_perm_b32 v35, v76, v72, s55
    v_perm_b32 v36, v52, v48, s56
    v_perm_b32 v37, v60, v56, s56
    v_perm_b32 v38, v68, v64, s56
    v_perm_b32 v39, v76, v72, s56
    v_mfma_f32_16x16x32_bf16 v[176:179], v[24:27], v[32:35], v[176:179]
    v_perm_b32 v40, v53, v49, s55
    v_perm_b32 v41, v61, v57, s55
    v_perm_b32 v42, v69, v65, s55
    v_perm_b32 v43, v77, v73, s55
    v_mfma_f32_16x16x32_bf16 v[180:183], v[24:27], v[36:39], v[180:183]
    v_perm_b32 v32, v53, v49, s56
    v_perm_b32 v33, v61, v57, s56
    v_perm_b32 v34, v69, v65, s56
    v_perm_b32 v35, v77, v73, s56
    v_mfma_f32_16x16x32_bf16 v[184:187], v[24:27], v[40:43], v[184:187]
    v_perm_b32 v36, v54, v50, s55
    v_perm_b32 v37, v62, v58, s55
    v_perm_b32 v38, v70, v66, s55
    v_perm_b32 v39, v78, v74, s55
    v_mfma_f32_16x16x32_bf16 v[188:191], v[24:27], v[32:35], v[188:191]
    v_perm_b32 v40, v54, v50, s56
    v_perm_b32 v41, v62, v58, s56
    v_perm_b32 v42, v70, v66, s56
    v_perm_b32 v43, v78, v74, s56
    v_mfma_f32_16x16x32_bf16 v[192:195], v[24:27], v[36:39], v[192:195]
    v_perm_b32 v32, v55, v51, s55
    v_perm_b32 v33, v63, v59, s55
    v_perm_b32 v34, v71, v67, s55
    v_perm_b32 v35, v79, v75, s55
    v_mfma_f32_16x16x32_bf16 v[196:199], v[24:27], v[40:43], v[196:199]
    v_perm_b32 v36, v55, v51, s56
    v_perm_b32 v37, v63, v59, s56
    v_perm_b32 v38, v71, v67, s56
    v_perm_b32 v39, v79, v75, s56
    v_mfma_f32_16x16x32_bf16 v[200:203], v[24:27], v[32:35], v[200:203]
    s_nop 1
    v_mfma_f32_16x16x32_bf16 v[204:207], v[24:27], v[36:39], v[204:207]
    v_perm_b32 v32, v84, v80, s55
    v_perm_b32 v33, v92, v88, s55
    v_perm_b32 v34, v100, v96, s55
    v_perm_b32 v35, v108, v104, s55
    v_perm_b32 v36, v84, v80, s56
    v_perm_b32 v37, v92, v88, s56
    v_perm_b32 v38, v100, v96, s56
    v_perm_b32 v39, v108, v104, s56
    v_mfma_f32_16x16x32_bf16 v[176:179], v[28:31], v[32:35], v[176:179]
    v_perm_b32 v40, v85, v81, s55
    v_perm_b32 v41, v93, v89, s55
    v_perm_b32 v42, v101, v97, s55
    v_perm_b32 v43, v109, v105, s55
    v_mfma_f32_16x16x32_bf16 v[180:183], v[28:31], v[36:39], v[180:183]
    v_perm_b32 v32, v85, v81, s56
    v_perm_b32 v33, v93, v89, s56
    v_perm_b32 v34, v101, v97, s56
    v_perm_b32 v35, v109, v105, s56
    v_mfma_f32_16x16x32_bf16 v[184:187], v[28:31], v[40:43], v[184:187]
    v_perm_b32 v36, v86, v82, s55
    v_perm_b32 v37, v94, v90, s55
    v_perm_b32 v38, v102, v98, s55
    v_perm_b32 v39, v110, v106, s55
    v_mfma_f32_16x16x32_bf16 v[188:191], v[28:31], v[32:35], v[188:191]
    v_perm_b32 v40, v86, v82, s56
    v_perm_b32 v41, v94, v90, s56
    v_perm_b32 v42, v102, v98, s56
    v_perm_b32 v43, v110, v106, s56
    v_mfma_f32_16x16x32_bf16 v[192:195], v[28:31], v[36:39], v[192:195]
    v_perm_b32 v32, v87, v83, s55
    v_perm_b32 v33, v95, v91, s55
    v_perm_b32 v34, v103, v99, s55
    v_perm_b32 v35, v111, v107, s55
    v_mfma_f32_16x16x32_bf16 v[196:199], v[28:31], v[40:43], v[196:199]
    v_perm_b32 v36, v87, v83, s56
    v_perm_b32 v37, v95, v91, s56
    v_perm_b32 v38, v103, v99, s56
    v_perm_b32 v39, v111, v107, s56
    v_mfma_f32_16x16x32_bf16 v[200:203], v[28:31], v[32:35], v[200:203]
    s_nop 1
    v_mfma_f32_16x16x32_bf16 v[204:207], v[28:31], v[36:39], v[204:207]
    s_branch M_pub
M_drain0:
    s_barrier
    s_lshl_b32 s70, s2, 12
    s_add_u32 s70, s70, 262144
    s_lshl_b32 s72, s2, 7
    s_add_u32 s72, s72, 1310720
    s_waitcnt vmcnt(48)
    v_mfma_f32_16x16x32_bf16 v[16:19], a[0:3], a[128:131], 0
    v_mfma_f32_16x16x32_bf16 v[16:19], a[4:7], a[132:135], v[16:19]
    v_mfma_f32_16x16x32_bf16 v[16:19], a[8:11], a[136:139], v[16:19]
    v_mfma_f32_16x16x32_bf16 v[16:19], a[12:15], a[140:143], v[16:19]
    v_mfma_f32_16x16x32_bf16 v[16:19], a[16:19], a[144:147], v[16:19]
    v_mfma_f32_16x16x32_bf16 v[16:19], a[20:23], a[148:151], v[16:19]
    v_mfma_f32_16x16x32_bf16 v[16:19], a[24:27], a[152:155], v[16:19]
    v_mfma_f32_16x16x32_bf16 v[16:19], a[28:31], a[156:159], v[16:19]
    v_mfma_f32_16x16x32_bf16 v[20:23], a[32:35], a[128:131], 0
    v_mfma_f32_16x16x32_bf16 v[20:23], a[36:39], a[132:135], v[20:23]
    v_mfma_f32_16x16x32_bf16 v[20:23], a[40:43], a[136:139], v[20:23]
    v_mfma_f32_16x16x32_bf16 v[20:23], a[44:47], a[140:143], v[20:23]
    v_mfma_f32_16x16x32_bf16 v[20:23], a[48:51], a[144:147], v[20:23]
    v_mfma_f32_16x16x32_bf16 v[20:23], a[52:55], a[148:151], v[20:23]
    v_mfma_f32_16x16x32_bf16 v[20:23], a[56:59], a[152:155], v[20:23]
    v_mfma_f32_16x16x32_bf16 v[20:23], a[60:63], a[156:159], v[20:23]
    s_nop 6
    v_cvt_pk_bf16_f32 v24, v16, v17
    v_cvt_pk_bf16_f32 v25, v18, v19
    v_cvt_pk_bf16_f32 v26, v20, v21
    v_cvt_pk_bf16_f32 v27, v22, v23
    v_lshlrev_b32 v16, 16, v24
    v_and_b32 v17, 0xffff0000, v24
    v_lshlrev_b32 v18, 16, v25
    v_and_b32 v19, 0xffff0000, v25
    v_lshlrev_b32 v20, 16, v26
    v_and_b32 v21, 0xffff0000, v26
    v_lshlrev_b32 v22, 16, v27
    v_and_b32 v23, 0xffff0000, v27
    v_max3_f32 v7, v16, v17, v18
    v_max3_f32 v7, v7, v19, v20
    v_max3_f32 v7, v7, v21, v22
    v_max_f32 v7, v7, v23
    v_mov_b32 v8, v7
    s_nop 1
    v_permlane16_swap_b32 v7, v8
    s_nop 0
    v_max_f32 v7, v7, v8
    v_mov_b32 v8, v7
    s_nop 1
    v_permlane32_swap_b32 v7, v8
    s_nop 0
    v_max_f32 v7, v7, v8
    v_mul_f32 v7, s54, v7
    v_max_f32 v7, v3, v7
    v_sub_f32 v8, v3, v7
    v_exp_f32 v10, v8
    v_mov_b32 v3, v7
    v_fma_f32 v16, v16, s54, -v7
    v_fma_f32 v17, v17, s54, -v7
    v_fma_f32 v18, v18, s54, -v7
    v_fma_f32 v19, v19, s54, -v7
    v_fma_f32 v20, v20, s54, -v7
    v_fma_f32 v21, v21, s54, -v7
    v_fma_f32 v22, v22, s54, -v7
    v_fma_f32 v23, v23, s54, -v7
    v_exp_f32 v16, v16
    v_exp_f32 v17, v17
    v_exp_f32 v18, v18
    v_exp_f32 v19, v19
    v_exp_f32 v20, v20
    v_exp_f32 v21, v21
    v_exp_f32 v22, v22
    v_exp_f32 v23, v23
    v_mov_b32_dpp v44, v10 quad_perm:[0,0,2,2] row_mask:0xf bank_mask:0xf
    v_mov_b32_dpp v45, v10 quad_perm:[1,1,3,3] row_mask:0xf bank_mask:0xf
    v_cvt_pk_bf16_f32 v28, v16, v17
    v_cvt_pk_bf16_f32 v29, v18, v19
    v_cvt_pk_bf16_f32 v30, v20, v21
    v_cvt_pk_bf16_f32 v31, v22, v23
    v_add_f32 v8, v16, v17
    v_add_f32 v9, v18, v19
    v_add_f32 v7, v20, v21
    v_add_f32 v8, v8, v9
    v_add_f32 v9, v22, v23
    v_add_f32 v7, v7, v9
    v_add_f32 v8, v8, v7
    v_fma_f32 v4, v4, v10, v8
    v_and_b32 v24, v5, v28
    v_and_b32 v28, v6, v28
    v_and_b32 v25, v5, v29
    v_and_b32 v29, v6, v29
    v_and_b32 v26, v5, v30
    v_and_b32 v30, v6, v30
    v_and_b32 v27, v5, v31
    v_and_b32 v31, v6, v31
    v_pk_mul_f32 v[176:177], v[176:177], v[44:45]
    v_pk_mul_f32 v[178:179], v[178:179], v[44:45]
    v_pk_mul_f32 v[180:181], v[180:181], v[44:45]
    v_pk_mul_f32 v[182:183], v[182:183], v[44:45]
    v_pk_mul_f32 v[184:185], v[184:185], v[44:45]
    v_pk_mul_f32 v[186:187], v[186:187], v[44:45]
    v_pk_mul_f32 v[188:189], v[188:189], v[44:45]
    v_pk_mul_f32 v[190:191], v[190:191], v[44:45]
    v_pk_mul_f32 v[192:193], v[192:193], v[44:45]
    v_pk_mul_f32 v[194:195], v[194:195], v[44:45]
    v_pk_mul_f32 v[196:197], v[196:197], v[44:45]
    v_pk_mul_f32 v[198:199], v[198:199], v[44:45]
    v_pk_mul_f32 v[200:201], v[200:201], v[44:45]
    v_pk_mul_f32 v[202:203], v[202:203], v[44:45]
    v_pk_mul_f32 v[204:205], v[204:205], v[44:45]
    v_pk_mul_f32 v[206:207], v[206:207], v[44:45]
    s_waitcnt vmcnt(32)
    v_perm_b32 v32, v52, v48, s55
    v_perm_b32 v33, v60, v56, s55
    v_perm_b32 v34, v68, v64, s55
    v_perm_b32 v35, v76, v72, s55
    v_perm_b32 v36, v52, v48, s56
    v_perm_b32 v37, v60, v56, s56
    v_perm_b32 v38, v68, v64, s56
    v_perm_b32 v39, v76, v72, s56
    v_mfma_f32_16x16x32_bf16 v[176:179], v[24:27], v[32:35], v[176:179]
    v_perm_b32 v40, v53, v49, s55
    v_perm_b32 v41, v61, v57, s55
    v_perm_b32 v42, v69, v65, s55
    v_perm_b32 v43, v77, v73, s55
    v_mfma_f32_16x16x32_bf16 v[180:183], v[24:27], v[36:39], v[180:183]
    v_perm_b32 v32, v53, v49, s56
    v_perm_b32 v33, v61, v57, s56
    v_perm_b32 v34, v69, v65, s56
    v_perm_b32 v35, v77, v73, s56
    v_mfma_f32_16x16x32_bf16 v[184:187], v[24:27], v[40:43], v[184:187]
    v_perm_b32 v36, v54, v50, s55
    v_perm_b32 v37, v62, v58, s55
    v_perm_b32 v38, v70, v66, s55
    v_perm_b32 v39, v78, v74, s55
    v_mfma_f32_16x16x32_bf16 v[188:191], v[24:27], v[32:35], v[188:191]
    v_perm_b32 v40, v54, v50, s56
    v_perm_b32 v41, v62, v58, s56
    v_perm_b32 v42, v70, v66, s56
    v_perm_b32 v43, v78, v74, s56
    v_mfma_f32_16x16x32_bf16 v[192:195], v[24:27], v[36:39], v[192:195]
    v_perm_b32 v32, v55, v51, s55
    v_perm_b32 v33, v63, v59, s55
    v_perm_b32 v34, v71, v67, s55
    v_perm_b32 v35, v79, v75, s55
    v_mfma_f32_16x16x32_bf16 v[196:199], v[24:27], v[40:43], v[196:199]
    v_perm_b32 v36, v55, v51, s56
    v_perm_b32 v37, v63, v59, s56
    v_perm_b32 v38, v71, v67, s56
    v_perm_b32 v39, v79, v75, s56
    v_mfma_f32_16x16x32_bf16 v[200:203], v[24:27], v[32:35], v[200:203]
    s_nop 1
    v_mfma_f32_16x16x32_bf16 v[204:207], v[24:27], v[36:39], v[204:207]
    v_perm_b32 v32, v84, v80, s55
    v_perm_b32 v33, v92, v88, s55
    v_perm_b32 v34, v100, v96, s55
    v_perm_b32 v35, v108, v104, s55
    v_perm_b32 v36, v84, v80, s56
    v_perm_b32 v37, v92, v88, s56
    v_perm_b32 v38, v100, v96, s56
    v_perm_b32 v39, v108, v104, s56
    v_mfma_f32_16x16x32_bf16 v[176:179], v[28:31], v[32:35], v[176:179]
    v_perm_b32 v40, v85, v81, s55
    v_perm_b32 v41, v93, v89, s55
    v_perm_b32 v42, v101, v97, s55
    v_perm_b32 v43, v109, v105, s55
    v_mfma_f32_16x16x32_bf16 v[180:183], v[28:31], v[36:39], v[180:183]
    v_perm_b32 v32, v85, v81, s56
    v_perm_b32 v33, v93, v89, s56
    v_perm_b32 v34, v101, v97, s56
    v_perm_b32 v35, v109, v105, s56
    v_mfma_f32_16x16x32_bf16 v[184:187], v[28:31], v[40:43], v[184:187]
    v_perm_b32 v36, v86, v82, s55
    v_perm_b32 v37, v94, v90, s55
    v_perm_b32 v38, v102, v98, s55
    v_perm_b32 v39, v110, v106, s55
    v_mfma_f32_16x16x32_bf16 v[188:191], v[28:31], v[32:35], v[188:191]
    v_perm_b32 v40, v86, v82, s56
    v_perm_b32 v41, v94, v90, s56
    v_perm_b32 v42, v102, v98, s56
    v_perm_b32 v43, v110, v106, s56
    v_mfma_f32_16x16x32_bf16 v[192:195], v[28:31], v[36:39], v[192:195]
    v_perm_b32 v32, v87, v83, s55
    v_perm_b32 v33, v95, v91, s55
    v_perm_b32 v34, v103, v99, s55
    v_perm_b32 v35, v111, v107, s55
    v_mfma_f32_16x16x32_bf16 v[196:199], v[28:31], v[40:43], v[196:199]
    v_perm_b32 v36, v87, v83, s56
    v_perm_b32 v37, v95, v91, s56
    v_perm_b32 v38, v103, v99, s56
    v_perm_b32 v39, v111, v107, s56
    v_mfma_f32_16x16x32_bf16 v[200:203], v[28:31], v[32:35], v[200:203]
    s_nop 1
    v_mfma_f32_16x16x32_bf16 v[204:207], v[28:31], v[36:39], v[204:207]
    s_waitcnt vmcnt(16)
    v_mfma_f32_16x16x32_bf16 v[16:19], a[64:67], a[128:131], 0
    v_mfma_f32_16x16x32_bf16 v[16:19], a[68:71], a[132:135], v[16:19]
    v_mfma_f32_16x16x32_bf16 v[16:19], a[72:75], a[136:139], v[16:19]
    v_mfma_f32_16x16x32_bf16 v[16:19], a[76:79], a[140:143], v[16:19]
    v_mfma_f32_16x16x32_bf16 v[16:19], a[80:83], a[144:147], v[16:19]
    v_mfma_f32_16x16x32_bf16 v[16:19], a[84:87], a[148:151], v[16:19]
    v_mfma_f32_16x16x32_bf16 v[16:19], a[88:91], a[152:155], v[16:19]
    v_mfma_f32_16x16x32_bf16 v[16:19], a[92:95], a[156:159], v[16:19]
    v_mfma_f32_16x16x32_bf16 v[20:23], a[96:99], a[128:131], 0
    v_mfma_f32_16x16x32_bf16 v[20:23], a[100:103], a[132:135], v[20:23]
    v_mfma_f32_16x16x32_bf16 v[20:23], a[104:107], a[136:139], v[20:23]
    v_mfma_f32_16x16x32_bf16 v[20:23], a[108:111], a[140:143], v[20:23]
    v_mfma_f32_16x16x32_bf16 v[20:23], a[112:115], a[144:147], v[20:23]
    v_mfma_f32_16x16x32_bf16 v[20:23], a[116:119], a[148:151], v[20:23]
    v_mfma_f32_16x16x32_bf16 v[20:23], a[120:123], a[152:155], v[20:23]
    v_mfma_f32_16x16x32_bf16 v[20:23], a[124:127], a[156:159], v[20:23]
    s_nop 6
    v_cvt_pk_bf16_f32 v24, v16, v17
    v_cvt_pk_bf16_f32 v25, v18, v19
    v_cvt_pk_bf16_f32 v26, v20, v21
    v_cvt_pk_bf16_f32 v27, v22, v23
    v_lshlrev_b32 v16, 16, v24
    v_and_b32 v17, 0xffff0000, v24
    v_lshlrev_b32 v18, 16, v25
    v_and_b32 v19, 0xffff0000, v25
    v_lshlrev_b32 v20, 16, v26
    v_and_b32 v21, 0xffff0000, v26
    v_lshlrev_b32 v22, 16, v27
    v_and_b32 v23, 0xffff0000, v27
    v_max3_f32 v7, v16, v17, v18
    v_max3_f32 v7, v7, v19, v20
    v_max3_f32 v7, v7, v21, v22
    v_max_f32 v7, v7, v23
    v_mov_b32 v8, v7
    s_nop 1
    v_permlane16_swap_b32 v7, v8
    s_nop 0
    v_max_f32 v7, v7, v8
    v_mov_b32 v8, v7
    s_nop 1
    v_permlane32_swap_b32 v7, v8
    s_nop 0
    v_max_f32 v7, v7, v8
    v_mul_f32 v7, s54, v7
    v_max_f32 v7, v3, v7
    v_sub_f32 v8, v3, v7
    v_exp_f32 v10, v8
    v_mov_b32 v3, v7
    v_fma_f32 v16, v16, s54, -v7
    v_fma_f32 v17, v17, s54, -v7
    v_fma_f32 v18, v18, s54, -v7
    v_fma_f32 v19, v19, s54, -v7
    v_fma_f32 v20, v20, s54, -v7
    v_fma_f32 v21, v21, s54, -v7
    v_fma_f32 v22, v22, s54, -v7
    v_fma_f32 v23, v23, s54, -v7
    v_exp_f32 v16, v16
    v_exp_f32 v17, v17
    v_exp_f32 v18, v18
    v_exp_f32 v19, v19
    v_exp_f32 v20, v20
    v_exp_f32 v21, v21
    v_exp_f32 v22, v22
    v_exp_f32 v23, v23
    v_mov_b32_dpp v44, v10 quad_perm:[0,0,2,2] row_mask:0xf bank_mask:0xf
    v_mov_b32_dpp v45, v10 quad_perm:[1,1,3,3] row_mask:0xf bank_mask:0xf
    v_cvt_pk_bf16_f32 v28, v16, v17
    v_cvt_pk_bf16_f32 v29, v18, v19
    v_cvt_pk_bf16_f32 v30, v20, v21
    v_cvt_pk_bf16_f32 v31, v22, v23
    v_add_f32 v8, v16, v17
    v_add_f32 v9, v18, v19
    v_add_f32 v7, v20, v21
    v_add_f32 v8, v8, v9
    v_add_f32 v9, v22, v23
    v_add_f32 v7, v7, v9
    v_add_f32 v8, v8, v7
    v_fma_f32 v4, v4, v10, v8
    v_and_b32 v24, v5, v28
    v_and_b32 v28, v6, v28
    v_and_b32 v25, v5, v29
    v_and_b32 v29, v6, v29
    v_and_b32 v26, v5, v30
    v_and_b32 v30, v6, v30
    v_and_b32 v27, v5, v31
    v_and_b32 v31, v6, v31
    v_pk_mul_f32 v[176:177], v[176:177], v[44:45]
    v_pk_mul_f32 v[178:179], v[178:179], v[44:45]
    v_pk_mul_f32 v[180:181], v[180:181], v[44:45]
    v_pk_mul_f32 v[182:183], v[182:183], v[44:45]
    v_pk_mul_f32 v[184:185], v[184:185], v[44:45]
    v_pk_mul_f32 v[186:187], v[186:187], v[44:45]
    v_pk_mul_f32 v[188:189], v[188:189], v[44:45]
    v_pk_mul_f32 v[190:191], v[190:191], v[44:45]
    v_pk_mul_f32 v[192:193], v[192:193], v[44:45]
    v_pk_mul_f32 v[194:195], v[194:195], v[44:45]
    v_pk_mul_f32 v[196:197], v[196:197], v[44:45]
    v_pk_mul_f32 v[198:199], v[198:199], v[44:45]
    v_pk_mul_f32 v[200:201], v[200:201], v[44:45]
    v_pk_mul_f32 v[202:203], v[202:203], v[44:45]
    v_pk_mul_f32 v[204:205], v[204:205], v[44:45]
    v_pk_mul_f32 v[206:207], v[206:207], v[44:45]
    s_waitcnt vmcnt(0)
    v_perm_b32 v32, v116, v112, s55
    v_perm_b32 v33, v124, v120, s55
    v_perm_b32 v34, v132, v128, s55
    v_perm_b32 v35, v140, v136, s55
    v_perm_b32 v36, v116, v112, s56
    v_perm_b32 v37, v124, v120, s56
    v_perm_b32 v38, v132, v128, s56
    v_perm_b32 v39, v140, v136, s56
    v_mfma_f32_16x16x32_bf16 v[176:179], v[24:27], v[32:35], v[176:179]
    v_perm_b32 v40, v117, v113, s55
    v_perm_b32 v41, v125, v121, s55
    v_perm_b32 v42, v133, v129, s55
    v_perm_b32 v43, v141, v137, s55
    v_mfma_f32_16x16x32_bf16 v[180:183], v[24:27], v[36:39], v[180:183]
    v_perm_b32 v32, v117, v113, s56
    v_perm_b32 v33, v125, v121, s56
    v_perm_b32 v34, v133, v129, s56
    v_perm_b32 v35, v141, v137, s56
    v_mfma_f32_16x16x32_bf16 v[184:187], v[24:27], v[40:43], v[184:187]
    v_perm_b32 v36, v118, v114, s55
    v_perm_b32 v37, v126, v122, s55
    v_perm_b32 v38, v134, v130, s55
    v_perm_b32 v39, v142, v138, s55
    v_mfma_f32_16x16x32_bf16 v[188:191], v[24:27], v[32:35], v[188:191]
    v_perm_b32 v40, v118, v114, s56
    v_perm_b32 v41, v126, v122, s56
    v_perm_b32 v42, v134, v130, s56
    v_perm_b32 v43, v142, v138, s56
    v_mfma_f32_16x16x32_bf16 v[192:195], v[24:27], v[36:39], v[192:195]
    v_perm_b32 v32, v119, v115, s55
    v_perm_b32 v33, v127, v123, s55
    v_perm_b32 v34, v135, v131, s55
    v_perm_b32 v35, v143, v139, s55
    v_mfma_f32_16x16x32_bf16 v[196:199], v[24:27], v[40:43], v[196:199]
    v_perm_b32 v36, v119, v115, s56
    v_perm_b32 v37, v127, v123, s56
    v_perm_b32 v38, v135, v131, s56
    v_perm_b32 v39, v143, v139, s56
    v_mfma_f32_16x16x32_bf16 v[200:203], v[24:27], v[32:35], v[200:203]
    s_nop 1
    v_mfma_f32_16x16x32_bf16 v[204:207], v[24:27], v[36:39], v[204:207]
    v_perm_b32 v32, v148, v144, s55
    v_perm_b32 v33, v156, v152, s55
    v_perm_b32 v34, v164, v160, s55
    v_perm_b32 v35, v172, v168, s55
    v_perm_b32 v36, v148, v144, s56
    v_perm_b32 v37, v156, v152, s56
    v_perm_b32 v38, v164, v160, s56
    v_perm_b32 v39, v172, v168, s56
    v_mfma_f32_16x16x32_bf16 v[176:179], v[28:31], v[32:35], v[176:179]
    v_perm_b32 v40, v149, v145, s55
    v_perm_b32 v41, v157, v153, s55
    v_perm_b32 v42, v165, v161, s55
    v_perm_b32 v43, v173, v169, s55
    v_mfma_f32_16x16x32_bf16 v[180:183], v[28:31], v[36:39], v[180:183]
    v_perm_b32 v32, v149, v145, s56
    v_perm_b32 v33, v157, v153, s56
    v_perm_b32 v34, v165, v161, s56
    v_perm_b32 v35, v173, v169, s56
    v_mfma_f32_16x16x32_bf16 v[184:187], v[28:31], v[40:43], v[184:187]
    v_perm_b32 v36, v150, v146, s55
    v_perm_b32 v37, v158, v154, s55
    v_perm_b32 v38, v166, v162, s55
    v_perm_b32 v39, v174, v170, s55
    v_mfma_f32_16x16x32_bf16 v[188:191], v[28:31], v[32:35], v[188:191]
    v_perm_b32 v40, v150, v146, s56
    v_perm_b32 v41, v158, v154, s56
    v_perm_b32 v42, v166, v162, s56
    v_perm_b32 v43, v174, v170, s56
    v_mfma_f32_16x16x32_bf16 v[192:195], v[28:31], v[36:39], v[192:195]
    v_perm_b32 v32, v151, v147, s55
    v_perm_b32 v33, v159, v155, s55
    v_perm_b32 v34, v167, v163, s55
    v_perm_b32 v35, v175, v171, s55
    v_mfma_f32_16x16x32_bf16 v[196:199], v[28:31], v[40:43], v[196:199]
    v_perm_b32 v36, v151, v147, s56
    v_perm_b32 v37, v159, v155, s56
    v_perm_b32 v38, v167, v163, s56
    v_perm_b32 v39, v175, v171, s56
    v_mfma_f32_16x16x32_bf16 v[200:203], v[28:31], v[32:35], v[200:203]
    s_nop 1
    v_mfma_f32_16x16x32_bf16 v[204:207], v[28:31], v[36:39], v[204:207]
M_pub:
    v_mov_b32 v7, v4
    s_nop 1
    v_permlane16_swap_b32 v4, v7
    s_nop 0
    v_add_f32 v4, v4, v7
    v_mov_b32 v7, v4
    s_nop 1
    v_permlane32_swap_b32 v4, v7
    s_nop 0
    v_add_f32 v4, v4, v7
    v_mov_b32 v224, v3
    v_mov_b32 v226, v4
    s_cmp_eq_u32 s63, 2
    s_cbranch_scc0 M_pubx
    v_cndmask_b32 v8, v176, v177, s[64:65]
    v_cndmask_b32 v9, v178, v179, s[64:65]
    v_cndmask_b32 v208, v8, v9, s[66:67]
    v_cndmask_b32 v8, v180, v181, s[64:65]
    v_cndmask_b32 v9, v182, v183, s[64:65]
    v_cndmask_b32 v210, v8, v9, s[66:67]
    buffer_store_dwordx4 v[208:211], v15, s[28:31], s70 offen offset:0
    v_cndmask_b32 v8, v184, v185, s[64:65]
    v_cndmask_b32 v9, v186, v187, s[64:65]
    v_cndmask_b32 v212, v8, v9, s[66:67]
    v_cndmask_b32 v8, v188, v189, s[64:65]
    v_cndmask_b32 v9, v190, v191, s[64:65]
    v_cndmask_b32 v214, v8, v9, s[66:67]
    buffer_store_dwordx4 v[212:215], v15, s[28:31], s70 offen offset:1024
    v_cndmask_b32 v8, v192, v193, s[64:65]
    v_cndmask_b32 v9, v194, v195, s[64:65]
    v_cndmask_b32 v216, v8, v9, s[66:67]
    v_cndmask_b32 v8, v196, v197, s[64:65]
    v_cndmask_b32 v9, v198, v199, s[64:65]
    v_cndmask_b32 v218, v8, v9, s[66:67]
    buffer_store_dwordx4 v[216:219], v15, s[28:31], s70 offen offset:2048
    v_cndmask_b32 v8, v200, v201, s[64:65]
    v_cndmask_b32 v9, v202, v203, s[64:65]
    v_cndmask_b32 v220, v8, v9, s[66:67]
    v_cndmask_b32 v8, v204, v205, s[64:65]
    v_cndmask_b32 v9, v206, v207, s[64:65]
    v_cndmask_b32 v222, v8, v9, s[66:67]
    buffer_store_dwordx4 v[220:223], v15, s[28:31], s70 offen offset:3072
    s_mov_b64 exec, 3
    buffer_store_dwordx4 v[224:227], v15, s[28:31], s72 offen
    s_mov_b64 exec, -1
    s_branch M_pubd
M_pubx:
    v_cndmask_b32 v8, v176, v177, s[64:65]
    v_cndmask_b32 v9, v178, v179, s[64:65]
    v_cndmask_b32 v208, v8, v9, s[66:67]
    v_cndmask_b32 v8, v180, v181, s[64:65]
    v_cndmask_b32 v9, v182, v183, s[64:65]
    v_cndmask_b32 v210, v8, v9, s[66:67]
    buffer_store_dwordx4 v[208:211], v15, s[28:31], s70 offen offset:0 sc1
    v_cndmask_b32 v8, v184, v185, s[64:65]
    v_cndmask_b32 v9, v186, v187, s[64:65]
    v_cndmask_b32 v212, v8, v9, s[66:67]
    v_cndmask_b32 v8, v188, v189, s[64:65]
    v_cndmask_b32 v9, v190, v191, s[64:65]
    v_cndmask_b32 v214, v8, v9, s[66:67]
    buffer_store_dwordx4 v[212:215], v15, s[28:31], s70 offen offset:1024 sc1
    v_cndmask_b32 v8, v192, v193, s[64:65]
    v_cndmask_b32 v9, v194, v195, s[64:65]
    v_cndmask_b32 v216, v8, v9, s[66:67]
    v_cndmask_b32 v8, v196, v197, s[64:65]
    v_cndmask_b32 v9, v198, v199, s[64:65]
    v_cndmask_b32 v218, v8, v9, s[66:67]
    buffer_store_dwordx4 v[216:219], v15, s[28:31], s70 offen offset:2048 sc1
    v_cndmask_b32 v8, v200, v201, s[64:65]
    v_cndmask_b32 v9, v202, v203, s[64:65]
    v_cndmask_b32 v220, v8, v9, s[66:67]
    v_cndmask_b32 v8, v204, v205, s[64:65]
    v_cndmask_b32 v9, v206, v207, s[64:65]
    v_cndmask_b32 v222, v8, v9, s[66:67]
    buffer_store_dwordx4 v[220:223], v15, s[28:31], s70 offen offset:3072 sc1
    s_mov_b64 exec, 3
    buffer_store_dwordx4 v[224:227], v15, s[28:31], s72 offen sc1
    s_mov_b64 exec, -1
M_pubd:
    v_mov_b32 v8, 25872
    v_mov_b32 v9, 1
    ds_write_b32 v8, v9
    s_branch M_fin
M_w1:
    v_mov_b32 v3, 0xff7fffff
    v_mov_b32 v4, 0
    v_and_b32 v7, 2, v46
    v_cmp_eq_u32 vcc, 0, v7
    v_and_b32 v8, 1, v47
    v_and_b32 v9, 2, v47
    v_cmp_ne_u32 s[64:65], 0, v8
    v_cmp_ne_u32 s[66:67], 0, v9
    v_cndmask_b32 v5, 0, -1, vcc
    v_not_b32 v6, v5
    v_mov_b32 v176, 0
    v_mov_b32 v177, 0
    v_mov_b32 v178, 0
    v_mov_b32 v179, 0
    v_mov_b32 v180, 0
    v_mov_b32 v181, 0
    v_mov_b32 v182, 0
    v_mov_b32 v183, 0
    v_mov_b32 v184, 0
    v_mov_b32 v185, 0
    v_mov_b32 v186, 0
    v_mov_b32 v187, 0
    v_mov_b32 v188, 0
    v_mov_b32 v189, 0
    v_mov_b32 v190, 0
    v_mov_b32 v191, 0
    v_mov_b32 v192, 0
    v_mov_b32 v193, 0
    v_mov_b32 v194, 0
    v_mov_b32 v195, 0
    v_mov_b32 v196, 0
    v_mov_b32 v197, 0
    v_mov_b32 v198, 0
    v_mov_b32 v199, 0
    v_mov_b32 v200, 0
    v_mov_b32 v201, 0
    v_mov_b32 v202, 0
    v_mov_b32 v203, 0
    v_mov_b32 v204, 0
    v_mov_b32 v205, 0
    v_mov_b32 v206, 0
    v_mov_b32 v207, 0
    v_mov_b32 v8, 25856
    s_mov_b32 s75, 2097152
W_11:
    ds_read_b128 v[32:35], v8 offset:0
    s_sub_u32 s75, s75, 1
    s_cmp_eq_u32 s75, 0
    s_cbranch_scc1 M_end
    s_waitcnt lgkmcnt(0)
    v_readfirstlane_b32 s79, v34
    s_nop 0
    s_cmp_lg_u32 s79, 0
    s_cbranch_scc1 K_12
    s_sleep 1
    s_branch W_11
K_12:
    s_add_u32 s59, s57, 8192
    buffer_load_dwordx4 a[0:3], v1, s[20:23], s57 offen offset:0 nt
    buffer_load_dwordx4 a[4:7], v1, s[20:23], s57 offen offset:64 nt
    buffer_load_dwordx4 a[8:11], v1, s[20:23], s57 offen offset:128 nt
    buffer_load_dwordx4 a[12:15], v1, s[20:23], s57 offen offset:192 nt
    buffer_load_dwordx4 a[16:19], v1, s[20:23], s57 offen offset:256 nt
    buffer_load_dwordx4 a[20:23], v1, s[20:23], s57 offen offset:320 nt
    buffer_load_dwordx4 a[24:27], v1, s[20:23], s57 offen offset:384 nt
    buffer_load_dwordx4 a[28:31], v1, s[20:23], s57 offen offset:448 nt
    buffer_load_dwordx4 a[32:35], v1, s[20:23], s59 offen offset:0 nt
    buffer_load_dwordx4 a[36:39], v1, s[20:23], s59 offen offset:64 nt
    buffer_load_dwordx4 a[40:43], v1, s[20:23], s59 offen offset:128 nt
    buffer_load_dwordx4 a[44:47], v1, s[20:23], s59 offen offset:192 nt
    buffer_load_dwordx4 a[48:51], v1, s[20:23], s59 offen offset:256 nt
    buffer_load_dwordx4 a[52:55], v1, s[20:23], s59 offen offset:320 nt
    buffer_load_dwordx4 a[56:59], v1, s[20:23], s59 offen offset:384 nt
    buffer_load_dwordx4 a[60:63], v1, s[20:23], s59 offen offset:448 nt
    s_add_u32 s57, s57, 16384
    s_add_u32 s60, s58, 8192
    buffer_load_dwordx4 v[48:51], v2, s[24:27], s58 offen offset:0 nt
    buffer_load_dwordx4 v[80:83], v2, s[24:27], s58 offen offset:256 nt
    buffer_load_dwordx4 v[52:55], v2, s[24:27], s58 offen offset:512 nt
    buffer_load_dwordx4 v[84:87], v2, s[24:27], s58 offen offset:768 nt
    buffer_load_dwordx4 v[56:59], v2, s[24:27], s58 offen offset:1024 nt
    buffer_load_dwordx4 v[88:91], v2, s[24:27], s58 offen offset:1280 nt
    buffer_load_dwordx4 v[60:63], v2, s[24:27], s58 offen offset:1536 nt
    buffer_load_dwordx4 v[92:95], v2, s[24:27], s58 offen offset:1792 nt
    buffer_load_dwordx4 v[64:67], v2, s[24:27], s60 offen offset:0 nt
    buffer_load_dwordx4 v[96:99], v2, s[24:27], s60 offen offset:256 nt
    buffer_load_dwordx4 v[68:71], v2, s[24:27], s60 offen offset:512 nt
    buffer_load_dwordx4 v[100:103], v2, s[24:27], s60 offen offset:768 nt
    buffer_load_dwordx4 v[72:75], v2, s[24:27], s60 offen offset:1024 nt
    buffer_load_dwordx4 v[104:107], v2, s[24:27], s60 offen offset:1280 nt
    buffer_load_dwordx4 v[76:79], v2, s[24:27], s60 offen offset:1536 nt
    buffer_load_dwordx4 v[108:111], v2, s[24:27], s60 offen offset:1792 nt
    s_add_u32 s58, s58, 16384
    s_waitcnt vmcnt(16)
    s_add_u32 s59, s57, 8192
    buffer_load_dwordx4 a[64:67], v1, s[20:23], s57 offen offset:0 nt
    buffer_load_dwordx4 a[68:71], v1, s[20:23], s57 offen offset:64 nt
    buffer_load_dwordx4 a[72:75], v1, s[20:23], s57 offen offset:128 nt
    buffer_load_dwordx4 a[76:79], v1, s[20:23], s57 offen offset:192 nt
    buffer_load_dwordx4 a[80:83], v1, s[20:23], s57 offen offset:256 nt
    buffer_load_dwordx4 a[84:87], v1, s[20:23], s57 offen offset:320 nt
    buffer_load_dwordx4 a[88:91], v1, s[20:23], s57 offen offset:384 nt
    buffer_load_dwordx4 a[92:95], v1, s[20:23], s57 offen offset:448 nt
    buffer_load_dwordx4 a[96:99], v1, s[20:23], s59 offen offset:0 nt
    buffer_load_dwordx4 a[100:103], v1, s[20:23], s59 offen offset:64 nt
    buffer_load_dwordx4 a[104:107], v1, s[20:23], s59 offen offset:128 nt
    buffer_load_dwordx4 a[108:111], v1, s[20:23], s59 offen offset:192 nt
    buffer_load_dwordx4 a[112:115], v1, s[20:23], s59 offen offset:256 nt
    buffer_load_dwordx4 a[116:119], v1, s[20:23], s59 offen offset:320 nt
    buffer_load_dwordx4 a[120:123], v1, s[20:23], s59 offen offset:384 nt
    buffer_load_dwordx4 a[124:127], v1, s[20:23], s59 offen offset:448 nt
    s_add_u32 s57, s57, 16384
    s_waitcnt vmcnt(16)
    s_add_u32 s60, s58, 8192
    buffer_load_dwordx4 v[112:115], v2, s[24:27], s58 offen offset:0 nt
    buffer_load_dwordx4 v[144:147], v2, s[24:27], s58 offen offset:256 nt
    buffer_load_dwordx4 v[116:119], v2, s[24:27], s58 offen offset:512 nt
    buffer_load_dwordx4 v[148:151], v2, s[24:27], s58 offen offset:768 nt
    buffer_load_dwordx4 v[120:123], v2, s[24:27], s58 offen offset:1024 nt
    buffer_load_dwordx4 v[152:155], v2, s[24:27], s58 offen offset:1280 nt
    buffer_load_dwordx4 v[124:127], v2, s[24:27], s58 offen offset:1536 nt
    buffer_load_dwordx4 v[156:159], v2, s[24:27], s58 offen offset:1792 nt
    buffer_load_dwordx4 v[128:131], v2, s[24:27], s60 offen offset:0 nt
    buffer_load_dwordx4 v[160:163], v2, s[24:27], s60 offen offset:256 nt
    buffer_load_dwordx4 v[132:135], v2, s[24:27], s60 offen offset:512 nt
    buffer_load_dwordx4 v[164:167], v2, s[24:27], s60 offen offset:768 nt
    buffer_load_dwordx4 v[136:139], v2, s[24:27], s60 offen offset:1024 nt
    buffer_load_dwordx4 v[168:171], v2, s[24:27], s60 offen offset:1280 nt
    buffer_load_dwordx4 v[140:143], v2, s[24:27], s60 offen offset:1536 nt
    buffer_load_dwordx4 v[172:175], v2, s[24:27], s60 offen offset:1792 nt
    s_add_u32 s58, s58, 16384
    v_mov_b32 v8, 25856
    s_mov_b32 s75, 2097152
W_13:
    ds_read_b128 v[32:35], v8 offset:0
    s_sub_u32 s75, s75, 1
    s_cmp_eq_u32 s75, 0
    s_cbranch_scc1 M_end
    s_waitcnt lgkmcnt(0)
    v_readfirstlane_b32 s79, v32
    v_readfirstlane_b32 s52, v33
    s_cmp_lg_u32 s79, 0
    s_cbranch_scc1 K_14
    s_sleep 1
    s_branch W_13
K_14:
    v_and_b32 v7, 1, v46
    v_lshlrev_b32 v7, 9, v7
    v_lshl_add_u32 v7, v47, 4, v7
    ds_read_b128 a[128:131], v7 offset:26112
    ds_read_b128 a[132:135], v7 offset:26176
    ds_read_b128 a[136:139], v7 offset:26240
    ds_read_b128 a[140:143], v7 offset:26304
    ds_read_b128 a[144:147], v7 offset:26368
    ds_read_b128 a[148:151], v7 offset:26432
    ds_read_b128 a[152:155], v7 offset:26496
    ds_read_b128 a[156:159], v7 offset:26560
    s_waitcnt lgkmcnt(0)
    s_waitcnt vmcnt(48)
    v_mfma_f32_16x16x32_bf16 v[16:19], a[0:3], a[128:131], 0
    v_mfma_f32_16x16x32_bf16 v[16:19], a[4:7], a[132:135], v[16:19]
    v_mfma_f32_16x16x32_bf16 v[16:19], a[8:11], a[136:139], v[16:19]
    v_mfma_f32_16x16x32_bf16 v[16:19], a[12:15], a[140:143], v[16:19]
    v_mfma_f32_16x16x32_bf16 v[16:19], a[16:19], a[144:147], v[16:19]
    v_mfma_f32_16x16x32_bf16 v[16:19], a[20:23], a[148:151], v[16:19]
    v_mfma_f32_16x16x32_bf16 v[16:19], a[24:27], a[152:155], v[16:19]
    v_mfma_f32_16x16x32_bf16 v[16:19], a[28:31], a[156:159], v[16:19]
    v_mfma_f32_16x16x32_bf16 v[20:23], a[32:35], a[128:131], 0
    v_mfma_f32_16x16x32_bf16 v[20:23], a[36:39], a[132:135], v[20:23]
    v_mfma_f32_16x16x32_bf16 v[20:23], a[40:43], a[136:139], v[20:23]
    v_mfma_f32_16x16x32_bf16 v[20:23], a[44:47], a[140:143], v[20:23]
    v_mfma_f32_16x16x32_bf16 v[20:23], a[48:51], a[144:147], v[20:23]
    v_mfma_f32_16x16x32_bf16 v[20:23], a[52:55], a[148:151], v[20:23]
    v_mfma_f32_16x16x32_bf16 v[20:23], a[56:59], a[152:155], v[20:23]
    v_mfma_f32_16x16x32_bf16 v[20:23], a[60:63], a[156:159], v[20:23]
    s_nop 6
    v_cvt_pk_bf16_f32 v24, v16, v17
    v_cvt_pk_bf16_f32 v25, v18, v19
    v_cvt_pk_bf16_f32 v26, v20, v21
    v_cvt_pk_bf16_f32 v27, v22, v23
    v_lshlrev_b32 v16, 16, v24
    v_and_b32 v17, 0xffff0000, v24
    v_lshlrev_b32 v18, 16, v25
    v_and_b32 v19, 0xffff0000, v25
    v_lshlrev_b32 v20, 16, v26
    v_and_b32 v21, 0xffff0000, v26
    v_lshlrev_b32 v22, 16, v27
    v_and_b32 v23, 0xffff0000, v27
    v_max3_f32 v7, v16, v17, v18
    v_max3_f32 v7, v7, v19, v20
    v_max3_f32 v7, v7, v21, v22
    v_max_f32 v7, v7, v23
    v_mov_b32 v8, v7
    s_nop 1
    v_permlane16_swap_b32 v7, v8
    s_nop 0
    v_max_f32 v7, v7, v8
    v_mov_b32 v8, v7
    s_nop 1
    v_permlane32_swap_b32 v7, v8
    s_nop 0
    v_max_f32 v7, v7, v8
    v_mul_f32 v7, s54, v7
    v_max_f32 v7, v3, v7
    v_sub_f32 v8, v3, v7
    v_exp_f32 v10, v8
    v_mov_b32 v3, v7
    v_fma_f32 v16, v16, s54, -v7
    v_fma_f32 v17, v17, s54, -v7
    v_fma_f32 v18, v18, s54, -v7
    v_fma_f32 v19, v19, s54, -v7
    v_fma_f32 v20, v20, s54, -v7
    v_fma_f32 v21, v21, s54, -v7
    v_fma_f32 v22, v22, s54, -v7
    v_fma_f32 v23, v23, s54, -v7
    v_exp_f32 v16, v16
    v_exp_f32 v17, v17
    v_exp_f32 v18, v18
    v_exp_f32 v19, v19
    v_exp_f32 v20, v20
    v_exp_f32 v21, v21
    v_exp_f32 v22, v22
    v_exp_f32 v23, v23
    v_mov_b32_dpp v44, v10 quad_perm:[0,0,2,2] row_mask:0xf bank_mask:0xf
    v_mov_b32_dpp v45, v10 quad_perm:[1,1,3,3] row_mask:0xf bank_mask:0xf
    v_cvt_pk_bf16_f32 v28, v16, v17
    v_cvt_pk_bf16_f32 v29, v18, v19
    v_cvt_pk_bf16_f32 v30, v20, v21
    v_cvt_pk_bf16_f32 v31, v22, v23
    v_add_f32 v8, v16, v17
    v_add_f32 v9, v18, v19
    v_add_f32 v7, v20, v21
    v_add_f32 v8, v8, v9
    v_add_f32 v9, v22, v23
    v_add_f32 v7, v7, v9
    v_add_f32 v8, v8, v7
    v_fma_f32 v4, v4, v10, v8
    v_and_b32 v24, v5, v28
    v_and_b32 v28, v6, v28
    v_and_b32 v25, v5, v29
    v_and_b32 v29, v6, v29
    v_and_b32 v26, v5, v30
    v_and_b32 v30, v6, v30
    v_and_b32 v27, v5, v31
    v_and_b32 v31, v6, v31
    v_pk_mul_f32 v[176:177], v[176:177], v[44:45]
    v_pk_mul_f32 v[178:179], v[178:179], v[44:45]
    v_pk_mul_f32 v[180:181], v[180:181], v[44:45]
    v_pk_mul_f32 v[182:183], v[182:183], v[44:45]
    v_pk_mul_f32 v[184:185], v[184:185], v[44:45]
    v_pk_mul_f32 v[186:187], v[186:187], v[44:45]
    v_pk_mul_f32 v[188:189], v[188:189], v[44:45]
    v_pk_mul_f32 v[190:191], v[190:191], v[44:45]
    v_pk_mul_f32 v[192:193], v[192:193], v[44:45]
    v_pk_mul_f32 v[194:195], v[194:195], v[44:45]
    v_pk_mul_f32 v[196:197], v[196:197], v[44:45]
    v_pk_mul_f32 v[198:199], v[198:199], v[44:45]
    v_pk_mul_f32 v[200:201], v[200:201], v[44:45]
    v_pk_mul_f32 v[202:203], v[202:203], v[44:45]
    v_pk_mul_f32 v[204:205], v[204:205], v[44:45]
    v_pk_mul_f32 v[206:207], v[206:207], v[44:45]
    s_waitcnt vmcnt(32)
    v_perm_b32 v32, v52, v48, s55
    v_perm_b32 v33, v60, v56, s55
    v_perm_b32 v34, v68, v64, s55
    v_perm_b32 v35, v76, v72, s55
    v_perm_b32 v36, v52, v48, s56
    v_perm_b32 v37, v60, v56, s56
    v_perm_b32 v38, v68, v64, s56
    v_perm_b32 v39, v76, v72, s56
    v_mfma_f32_16x16x32_bf16 v[176:179], v[24:27], v[32:35], v[176:179]
    v_perm_b32 v40, v53, v49, s55
    v_perm_b32 v41, v61, v57, s55
    v_perm_b32 v42, v69, v65, s55
    v_perm_b32 v43, v77, v73, s55
    v_mfma_f32_16x16x32_bf16 v[180:183], v[24:27], v[36:39], v[180:183]
    v_perm_b32 v32, v53, v49, s56
    v_perm_b32 v33, v61, v57, s56
    v_perm_b32 v34, v69, v65, s56
    v_perm_b32 v35, v77, v73, s56
    v_mfma_f32_16x16x32_bf16 v[184:187], v[24:27], v[40:43], v[184:187]
    v_perm_b32 v36, v54, v50, s55
    v_perm_b32 v37, v62, v58, s55
    v_perm_b32 v38, v70, v66, s55
    v_perm_b32 v39, v78, v74, s55
    v_mfma_f32_16x16x32_bf16 v[188:191], v[24:27], v[32:35], v[188:191]
    v_perm_b32 v40, v54, v50, s56
    v_perm_b32 v41, v62, v58, s56
    v_perm_b32 v42, v70, v66, s56
    v_perm_b32 v43, v78, v74, s56
    v_mfma_f32_16x16x32_bf16 v[192:195], v[24:27], v[36:39], v[192:195]
    v_perm_b32 v32, v55, v51, s55
    v_perm_b32 v33, v63, v59, s55
    v_perm_b32 v34, v71, v67, s55
    v_perm_b32 v35, v79, v75, s55
    v_mfma_f32_16x16x32_bf16 v[196:199], v[24:27], v[40:43], v[196:199]
    v_perm_b32 v36, v55, v51, s56
    v_perm_b32 v37, v63, v59, s56
    v_perm_b32 v38, v71, v67, s56
    v_perm_b32 v39, v79, v75, s56
    v_mfma_f32_16x16x32_bf16 v[200:203], v[24:27], v[32:35], v[200:203]
    s_nop 1
    v_mfma_f32_16x16x32_bf16 v[204:207], v[24:27], v[36:39], v[204:207]
    v_perm_b32 v32, v84, v80, s55
    v_perm_b32 v33, v92, v88, s55
    v_perm_b32 v34, v100, v96, s55
    v_perm_b32 v35, v108, v104, s55
    v_perm_b32 v36, v84, v80, s56
    v_perm_b32 v37, v92, v88, s56
    v_perm_b32 v38, v100, v96, s56
    v_perm_b32 v39, v108, v104, s56
    v_mfma_f32_16x16x32_bf16 v[176:179], v[28:31], v[32:35], v[176:179]
    v_perm_b32 v40, v85, v81, s55
    v_perm_b32 v41, v93, v89, s55
    v_perm_b32 v42, v101, v97, s55
    v_perm_b32 v43, v109, v105, s55
    v_mfma_f32_16x16x32_bf16 v[180:183], v[28:31], v[36:39], v[180:183]
    v_perm_b32 v32, v85, v81, s56
    v_perm_b32 v33, v93, v89, s56
    v_perm_b32 v34, v101, v97, s56
    v_perm_b32 v35, v109, v105, s56
    v_mfma_f32_16x16x32_bf16 v[184:187], v[28:31], v[40:43], v[184:187]
    v_perm_b32 v36, v86, v82, s55
    v_perm_b32 v37, v94, v90, s55
    v_perm_b32 v38, v102, v98, s55
    v_perm_b32 v39, v110, v106, s55
    v_mfma_f32_16x16x32_bf16 v[188:191], v[28:31], v[32:35], v[188:191]
    v_perm_b32 v40, v86, v82, s56
    v_perm_b32 v41, v94, v90, s56
    v_perm_b32 v42, v102, v98, s56
    v_perm_b32 v43, v110, v106, s56
    v_mfma_f32_16x16x32_bf16 v[192:195], v[28:31], v[36:39], v[192:195]
    v_perm_b32 v32, v87, v83, s55
    v_perm_b32 v33, v95, v91, s55
    v_perm_b32 v34, v103, v99, s55
    v_perm_b32 v35, v111, v107, s55
    v_mfma_f32_16x16x32_bf16 v[196:199], v[28:31], v[40:43], v[196:199]
    v_perm_b32 v36, v87, v83, s56
    v_perm_b32 v37, v95, v91, s56
    v_perm_b32 v38, v103, v99, s56
    v_perm_b32 v39, v111, v107, s56
    v_mfma_f32_16x16x32_bf16 v[200:203], v[28:31], v[32:35], v[200:203]
    s_nop 1
    v_mfma_f32_16x16x32_bf16 v[204:207], v[28:31], v[36:39], v[204:207]
    s_waitcnt vmcnt(16)
    v_mfma_f32_16x16x32_bf16 v[16:19], a[64:67], a[128:131], 0
    v_mfma_f32_16x16x32_bf16 v[16:19], a[68:71], a[132:135], v[16:19]
    v_mfma_f32_16x16x32_bf16 v[16:19], a[72:75], a[136:139], v[16:19]
    v_mfma_f32_16x16x32_bf16 v[16:19], a[76:79], a[140:143], v[16:19]
    v_mfma_f32_16x16x32_bf16 v[16:19], a[80:83], a[144:147], v[16:19]
    v_mfma_f32_16x16x32_bf16 v[16:19], a[84:87], a[148:151], v[16:19]
    v_mfma_f32_16x16x32_bf16 v[16:19], a[88:91], a[152:155], v[16:19]
    v_mfma_f32_16x16x32_bf16 v[16:19], a[92:95], a[156:159], v[16:19]
    v_mfma_f32_16x16x32_bf16 v[20:23], a[96:99], a[128:131], 0
    v_mfma_f32_16x16x32_bf16 v[20:23], a[100:103], a[132:135], v[20:23]
    v_mfma_f32_16x16x32_bf16 v[20:23], a[104:107], a[136:139], v[20:23]
    v_mfma_f32_16x16x32_bf16 v[20:23], a[108:111], a[140:143], v[20:23]
    v_mfma_f32_16x16x32_bf16 v[20:23], a[112:115], a[144:147], v[20:23]
    v_mfma_f32_16x16x32_bf16 v[20:23], a[116:119], a[148:151], v[20:23]
    v_mfma_f32_16x16x32_bf16 v[20:23], a[120:123], a[152:155], v[20:23]
    v_mfma_f32_16x16x32_bf16 v[20:23], a[124:127], a[156:159], v[20:23]
    s_nop 6
    v_cvt_pk_bf16_f32 v24, v16, v17
    v_cvt_pk_bf16_f32 v25, v18, v19
    v_cvt_pk_bf16_f32 v26, v20, v21
    v_cvt_pk_bf16_f32 v27, v22, v23
    v_lshlrev_b32 v16, 16, v24
    v_and_b32 v17, 0xffff0000, v24
    v_lshlrev_b32 v18, 16, v25
    v_and_b32 v19, 0xffff0000, v25
    v_lshlrev_b32 v20, 16, v26
    v_and_b32 v21, 0xffff0000, v26
    v_lshlrev_b32 v22, 16, v27
    v_and_b32 v23, 0xffff0000, v27
    v_max3_f32 v7, v16, v17, v18
    v_max3_f32 v7, v7, v19, v20
    v_max3_f32 v7, v7, v21, v22
    v_max_f32 v7, v7, v23
    v_mov_b32 v8, v7
    s_nop 1
    v_permlane16_swap_b32 v7, v8
    s_nop 0
    v_max_f32 v7, v7, v8
    v_mov_b32 v8, v7
    s_nop 1
    v_permlane32_swap_b32 v7, v8
    s_nop 0
    v_max_f32 v7, v7, v8
    v_mul_f32 v7, s54, v7
    v_max_f32 v7, v3, v7
    v_sub_f32 v8, v3, v7
    v_exp_f32 v10, v8
    v_mov_b32 v3, v7
    v_fma_f32 v16, v16, s54, -v7
    v_fma_f32 v17, v17, s54, -v7
    v_fma_f32 v18, v18, s54, -v7
    v_fma_f32 v19, v19, s54, -v7
    v_fma_f32 v20, v20, s54, -v7
    v_fma_f32 v21, v21, s54, -v7
    v_fma_f32 v22, v22, s54, -v7
    v_fma_f32 v23, v23, s54, -v7
    v_exp_f32 v16, v16
    v_exp_f32 v17, v17
    v_exp_f32 v18, v18
    v_exp_f32 v19, v19
    v_exp_f32 v20, v20
    v_exp_f32 v21, v21
    v_exp_f32 v22, v22
    v_exp_f32 v23, v23
    v_mov_b32_dpp v44, v10 quad_perm:[0,0,2,2] row_mask:0xf bank_mask:0xf
    v_mov_b32_dpp v45, v10 quad_perm:[1,1,3,3] row_mask:0xf bank_mask:0xf
    v_cvt_pk_bf16_f32 v28, v16, v17
    v_cvt_pk_bf16_f32 v29, v18, v19
    v_cvt_pk_bf16_f32 v30, v20, v21
    v_cvt_pk_bf16_f32 v31, v22, v23
    v_add_f32 v8, v16, v17
    v_add_f32 v9, v18, v19
    v_add_f32 v7, v20, v21
    v_add_f32 v8, v8, v9
    v_add_f32 v9, v22, v23
    v_add_f32 v7, v7, v9
    v_add_f32 v8, v8, v7
    v_fma_f32 v4, v4, v10, v8
    v_and_b32 v24, v5, v28
    v_and_b32 v28, v6, v28
    v_and_b32 v25, v5, v29
    v_and_b32 v29, v6, v29
    v_and_b32 v26, v5, v30
    v_and_b32 v30, v6, v30
    v_and_b32 v27, v5, v31
    v_and_b32 v31, v6, v31
    v_pk_mul_f32 v[176:177], v[176:177], v[44:45]
    v_pk_mul_f32 v[178:179], v[178:179], v[44:45]
    v_pk_mul_f32 v[180:181], v[180:181], v[44:45]
    v_pk_mul_f32 v[182:183], v[182:183], v[44:45]
    v_pk_mul_f32 v[184:185], v[184:185], v[44:45]
    v_pk_mul_f32 v[186:187], v[186:187], v[44:45]
    v_pk_mul_f32 v[188:189], v[188:189], v[44:45]
    v_pk_mul_f32 v[190:191], v[190:191], v[44:45]
    v_pk_mul_f32 v[192:193], v[192:193], v[44:45]
    v_pk_mul_f32 v[194:195], v[194:195], v[44:45]
    v_pk_mul_f32 v[196:197], v[196:197], v[44:45]
    v_pk_mul_f32 v[198:199], v[198:199], v[44:45]
    v_pk_mul_f32 v[200:201], v[200:201], v[44:45]
    v_pk_mul_f32 v[202:203], v[202:203], v[44:45]
    v_pk_mul_f32 v[204:205], v[204:205], v[44:45]
    v_pk_mul_f32 v[206:207], v[206:207], v[44:45]
    s_waitcnt vmcnt(0)
    v_perm_b32 v32, v116, v112, s55
    v_perm_b32 v33, v124, v120, s55
    v_perm_b32 v34, v132, v128, s55
    v_perm_b32 v35, v140, v136, s55
    v_perm_b32 v36, v116, v112, s56
    v_perm_b32 v37, v124, v120, s56
    v_perm_b32 v38, v132, v128, s56
    v_perm_b32 v39, v140, v136, s56
    v_mfma_f32_16x16x32_bf16 v[176:179], v[24:27], v[32:35], v[176:179]
    v_perm_b32 v40, v117, v113, s55
    v_perm_b32 v41, v125, v121, s55
    v_perm_b32 v42, v133, v129, s55
    v_perm_b32 v43, v141, v137, s55
    v_mfma_f32_16x16x32_bf16 v[180:183], v[24:27], v[36:39], v[180:183]
    v_perm_b32 v32, v117, v113, s56
    v_perm_b32 v33, v125, v121, s56
    v_perm_b32 v34, v133, v129, s56
    v_perm_b32 v35, v141, v137, s56
    v_mfma_f32_16x16x32_bf16 v[184:187], v[24:27], v[40:43], v[184:187]
    v_perm_b32 v36, v118, v114, s55
    v_perm_b32 v37, v126, v122, s55
    v_perm_b32 v38, v134, v130, s55
    v_perm_b32 v39, v142, v138, s55
    v_mfma_f32_16x16x32_bf16 v[188:191], v[24:27], v[32:35], v[188:191]
    v_perm_b32 v40, v118, v114, s56
    v_perm_b32 v41, v126, v122, s56
    v_perm_b32 v42, v134, v130, s56
    v_perm_b32 v43, v142, v138, s56
    v_mfma_f32_16x16x32_bf16 v[192:195], v[24:27], v[36:39], v[192:195]
    v_perm_b32 v32, v119, v115, s55
    v_perm_b32 v33, v127, v123, s55
    v_perm_b32 v34, v135, v131, s55
    v_perm_b32 v35, v143, v139, s55
    v_mfma_f32_16x16x32_bf16 v[196:199], v[24:27], v[40:43], v[196:199]
    v_perm_b32 v36, v119, v115, s56
    v_perm_b32 v37, v127, v123, s56
    v_perm_b32 v38, v135, v131, s56
    v_perm_b32 v39, v143, v139, s56
    v_mfma_f32_16x16x32_bf16 v[200:203], v[24:27], v[32:35], v[200:203]
    s_nop 1
    v_mfma_f32_16x16x32_bf16 v[204:207], v[24:27], v[36:39], v[204:207]
    v_perm_b32 v32, v148, v144, s55
    v_perm_b32 v33, v156, v152, s55
    v_perm_b32 v34, v164, v160, s55
    v_perm_b32 v35, v172, v168, s55
    v_perm_b32 v36, v148, v144, s56
    v_perm_b32 v37, v156, v152, s56
    v_perm_b32 v38, v164, v160, s56
    v_perm_b32 v39, v172, v168, s56
    v_mfma_f32_16x16x32_bf16 v[176:179], v[28:31], v[32:35], v[176:179]
    v_perm_b32 v40, v149, v145, s55
    v_perm_b32 v41, v157, v153, s55
    v_perm_b32 v42, v165, v161, s55
    v_perm_b32 v43, v173, v169, s55
    v_mfma_f32_16x16x32_bf16 v[180:183], v[28:31], v[36:39], v[180:183]
    v_perm_b32 v32, v149, v145, s56
    v_perm_b32 v33, v157, v153, s56
    v_perm_b32 v34, v165, v161, s56
    v_perm_b32 v35, v173, v169, s56
    v_mfma_f32_16x16x32_bf16 v[184:187], v[28:31], v[40:43], v[184:187]
    v_perm_b32 v36, v150, v146, s55
    v_perm_b32 v37, v158, v154, s55
    v_perm_b32 v38, v166, v162, s55
    v_perm_b32 v39, v174, v170, s55
    v_mfma_f32_16x16x32_bf16 v[188:191], v[28:31], v[32:35], v[188:191]
    v_perm_b32 v40, v150, v146, s56
    v_perm_b32 v41, v158, v154, s56
    v_perm_b32 v42, v166, v162, s56
    v_perm_b32 v43, v174, v170, s56
    v_mfma_f32_16x16x32_bf16 v[192:195], v[28:31], v[36:39], v[192:195]
    v_perm_b32 v32, v151, v147, s55
    v_perm_b32 v33, v159, v155, s55
    v_perm_b32 v34, v167, v163, s55
    v_perm_b32 v35, v175, v171, s55
    v_mfma_f32_16x16x32_bf16 v[196:199], v[28:31], v[40:43], v[196:199]
    v_perm_b32 v36, v151, v147, s56
    v_perm_b32 v37, v159, v155, s56
    v_perm_b32 v38, v167, v163, s56
    v_perm_b32 v39, v175, v171, s56
    v_mfma_f32_16x16x32_bf16 v[200:203], v[28:31], v[32:35], v[200:203]
    s_nop 1
    v_mfma_f32_16x16x32_bf16 v[204:207], v[28:31], v[36:39], v[204:207]
    v_lshlrev_b32 v11, 4, v0
    v_mov_b32 v32, v3
    v_mov_b32 v33, v4
    s_nop 5
    ds_write_b128 v11, v[176:179] offset:14336
    ds_write_b128 v11, v[180:183] offset:15360
    ds_write_b128 v11, v[184:187] offset:16384
    ds_write_b128 v11, v[188:191] offset:17408
    ds_write_b128 v11, v[192:195] offset:18432
    ds_write_b128 v11, v[196:199] offset:19456
    ds_write_b128 v11, v[200:203] offset:20480
    ds_write_b128 v11, v[204:207] offset:21504
    ds_write_b128 v11, v[32:35] offset:22528
    v_mov_b32 v8, 25868
    v_mov_b32 v9, 1
    ds_write_b32 v8, v9
    s_cmp_ge_u32 s2, 224
    s_cbranch_scc1 M_fin
    s_barrier
    s_and_b32 s70, s2, 28
    s_add_u32 s70, s70, 0
    s_and_b32 s71, s2, 3
    s_lshl_b32 s72, s70, 12
    s_and_b32 s76, s71, 1
    s_lshl_b32 s76, s76, 9
    s_add_u32 s72, s72, s76
    s_lshr_b32 s76, s71, 1
    s_lshl_b32 s76, s76, 8
    s_add_u32 s72, s72, s76
    s_add_u32 s72, s72, 262144
    s_lshl_b32 s73, s70, 7
    s_lshr_b32 s71, s71, 1
    s_lshl_b32 s71, s71, 4
    s_add_u32 s73, s73, s71
    s_add_u32 s73, s73, 1310720
    v_lshlrev_b32 v14, 10, v47
    v_lshl_add_u32 v14, v46, 4, v14
    v_min_u32 v15, 11, v46
    v_lshrrev_b32 v13, 2, v15
    v_lshlrev_b32 v13, 12, v13
    v_and_b32 v15, 3, v15
    v_lshl_add_u32 v15, v15, 7, v13
    v_lshlrev_b32 v13, 4, v46
    v_lshl_add_u32 v13, v47, 2, v13
    s_not_b32 s71, s52
    v_mov_b32 v49, s71
    v_mov_b32 v53, s71
    v_mov_b32 v57, s71
    v_mov_b32 v61, s71
    v_mov_b32 v65, s71
    v_mov_b32 v69, s71
    v_mov_b32 v73, s71
    v_mov_b32 v77, s71
    v_mov_b32 v81, s71
    v_mov_b32 v85, s71
    v_mov_b32 v89, s71
    v_mov_b32 v93, s71
    v_mov_b32 v176, 0
    v_mov_b32 v177, s71
    v_mov_b32 v178, 1.0
    v_mov_b32 v179, s71
    s_mov_b32 s74, 0
    s_mov_b32 s57, 0
    s_mov_b32 s58, 0
    v_mov_b32 v8, 25856
    s_mov_b32 s75, 2097152
W_15:
    ds_read_b128 v[32:35], v8 offset:16
    s_sub_u32 s75, s75, 1
    s_cmp_eq_u32 s75, 0
    s_cbranch_scc1 M_end
    s_waitcnt lgkmcnt(0)
    v_readfirstlane_b32 s79, v32
    s_nop 0
    s_cmp_lg_u32 s79, 0
    s_cbranch_scc1 K_16
    s_sleep 1
    s_branch W_15
K_16:
G_17:
    s_andn2_b32 s71, 4095, s58
    s_mov_b32 exec_lo, s71
    s_mov_b32 exec_hi, 0
    buffer_load_dwordx4 v[176:179], v15, s[28:31], s73 offen sc1
    s_mov_b64 exec, -1
    s_bcnt1_i32_b32 s71, s71
    s_cmp_le_u32 s71, 16
    s_cselect_b32 s59, 4095, s58
    s_andn2_b32 s59, s59, s57
    s_bfe_u32 s71, s59, 262144
    s_cbranch_scc0 GS_18
    s_bitcmp1_b32 s59, 0
    s_cselect_b64 exec, -1, 0
    s_add_u32 s71, s72, 0
    buffer_load_dwordx4 v[48:51], v14, s[28:31], s71 offen sc1
    s_bitcmp1_b32 s59, 1
    s_cselect_b64 exec, -1, 0
    s_add_u32 s71, s72, 4096
    buffer_load_dwordx4 v[52:55], v14, s[28:31], s71 offen sc1
    s_bitcmp1_b32 s59, 2
    s_cselect_b64 exec, -1, 0
    s_add_u32 s71, s72, 8192
    buffer_load_dwordx4 v[56:59], v14, s[28:31], s71 offen sc1
    s_bitcmp1_b32 s59, 3
    s_cselect_b64 exec, -1, 0
    s_add_u32 s71, s72, 12288
    buffer_load_dwordx4 v[60:63], v14, s[28:31], s71 offen sc1
    s_mov_b64 exec, -1
GS_18:
    s_bfe_u32 s71, s59, 262148
    s_cbranch_scc0 GS_19
    s_bitcmp1_b32 s59, 4
    s_cselect_b64 exec, -1, 0
    s_add_u32 s71, s72, 131072
    buffer_load_dwordx4 v[64:67], v14, s[28:31], s71 offen sc1
    s_bitcmp1_b32 s59, 5
    s_cselect_b64 exec, -1, 0
    s_add_u32 s71, s72, 135168
    buffer_load_dwordx4 v[68:71], v14, s[28:31], s71 offen sc1
    s_bitcmp1_b32 s59, 6
    s_cselect_b64 exec, -1, 0
    s_add_u32 s71, s72, 139264
    buffer_load_dwordx4 v[72:75], v14, s[28:31], s71 offen sc1
    s_bitcmp1_b32 s59, 7
    s_cselect_b64 exec, -1, 0
    s_add_u32 s71, s72, 143360
    buffer_load_dwordx4 v[76:79], v14, s[28:31], s71 offen sc1
    s_mov_b64 exec, -1
GS_19:
    s_bfe_u32 s71, s59, 262152
    s_cbranch_scc0 GS_20
    s_bitcmp1_b32 s59, 8
    s_cselect_b64 exec, -1, 0
    s_add_u32 s71, s72, 262144
    buffer_load_dwordx4 v[80:83], v14, s[28:31], s71 offen sc1
    s_bitcmp1_b32 s59, 9
    s_cselect_b64 exec, -1, 0
    s_add_u32 s71, s72, 266240
    buffer_load_dwordx4 v[84:87], v14, s[28:31], s71 offen sc1
    s_bitcmp1_b32 s59, 10
    s_cselect_b64 exec, -1, 0
    s_add_u32 s71, s72, 270336
    buffer_load_dwordx4 v[88:91], v14, s[28:31], s71 offen sc1
    s_bitcmp1_b32 s59, 11
    s_cselect_b64 exec, -1, 0
    s_add_u32 s71, s72, 274432
    buffer_load_dwordx4 v[92:95], v14, s[28:31], s71 offen sc1
    s_mov_b64 exec, -1
GS_20:
    s_waitcnt vmcnt(0)
    v_xor_b32 v9, s52, v177
    v_xor_b32 v10, s52, v179
    v_or_b32 v9, v9, v10
    v_cmp_eq_u32 vcc, 0, v9
    v_max_f32_dpp v9, v176, v176 quad_perm:[1,0,3,2] row_mask:0xf bank_mask:0xf
    s_and_b32 s58, vcc_lo, 4095
    s_nop 0
    v_max_f32_dpp v9, v9, v9 quad_perm:[2,3,0,1] row_mask:0xf bank_mask:0xf
    v_sub_f32 v9, v176, v9
    v_exp_f32 v9, v9
    s_nop 0
    v_mul_f32 v10, v9, v178
    s_nop 1
    v_add_f32_dpp v10, v10, v10 quad_perm:[1,0,3,2] row_mask:0xf bank_mask:0xf
    s_nop 1
    v_add_f32_dpp v10, v10, v10 quad_perm:[2,3,0,1] row_mask:0xf bank_mask:0xf
    v_rcp_f32 v10, v10
    s_nop 0
    v_mul_f32 v12, v9, v10
    s_bitcmp1_b32 s74, 0
    s_cbranch_scc1 GB_21
    v_xor_b32 v32, s52, v49
    v_xor_b32 v33, s52, v51
    v_xor_b32 v34, s52, v53
    v_xor_b32 v35, s52, v55
    v_xor_b32 v36, s52, v57
    v_xor_b32 v37, s52, v59
    v_xor_b32 v38, s52, v61
    v_xor_b32 v39, s52, v63
    v_or_b32 v32, v32, v33
    v_or_b32 v34, v34, v35
    v_or_b32 v36, v36, v37
    v_or_b32 v38, v38, v39
    v_cmp_ne_u32 s[4:5], 0, v32
    v_cmp_ne_u32 s[6:7], 0, v34
    v_cmp_ne_u32 s[8:9], 0, v36
    v_cmp_ne_u32 s[10:11], 0, v38
    v_readlane_b32 s96, v12, 0
    v_readlane_b32 s97, v12, 1
    v_readlane_b32 s98, v12, 2
    v_readlane_b32 s99, v12, 3
    s_cmp_eq_u64 s[4:5], 0
    s_cselect_b32 s71, 1, 0
    s_or_b32 s57, s57, s71
    s_cmp_eq_u64 s[6:7], 0
    s_cselect_b32 s71, 2, 0
    s_or_b32 s57, s57, s71
    s_cmp_eq_u64 s[8:9], 0
    s_cselect_b32 s71, 4, 0
    s_or_b32 s57, s57, s71
    s_cmp_eq_u64 s[10:11], 0
    s_cselect_b32 s71, 8, 0
    s_or_b32 s57, s57, s71
    v_mul_f32 v10, s96, v48
    v_mul_f32 v11, s96, v50
    s_and_b32 s71, s57, s58
    s_bfe_u32 s71, s71, 262144
    s_cmp_lg_u32 s71, 15
    s_cbranch_scc1 GB_21
    v_fmac_f32 v10, s97, v52
    v_fmac_f32 v11, s97, v54
    v_fmac_f32 v10, s98, v56
    v_fmac_f32 v11, s98, v58
    v_fmac_f32 v10, s99, v60
    v_fmac_f32 v11, s99, v62
    v_cvt_pk_bf16_f32 v10, v10, v11
    ds_write_b32 v13, v10 offset:23552
    s_bitset1_b32 s74, 0
GB_21:
    s_bitcmp1_b32 s74, 1
    s_cbranch_scc1 GB_22
    v_xor_b32 v32, s52, v65
    v_xor_b32 v33, s52, v67
    v_xor_b32 v34, s52, v69
    v_xor_b32 v35, s52, v71
    v_xor_b32 v36, s52, v73
    v_xor_b32 v37, s52, v75
    v_xor_b32 v38, s52, v77
    v_xor_b32 v39, s52, v79
    v_or_b32 v32, v32, v33
    v_or_b32 v34, v34, v35
    v_or_b32 v36, v36, v37
    v_or_b32 v38, v38, v39
    v_cmp_ne_u32 s[4:5], 0, v32
    v_cmp_ne_u32 s[6:7], 0, v34
    v_cmp_ne_u32 s[8:9], 0, v36
    v_cmp_ne_u32 s[10:11], 0, v38
    v_readlane_b32 s96, v12, 4
    v_readlane_b32 s97, v12, 5
    v_readlane_b32 s98, v12, 6
    v_readlane_b32 s99, v12, 7
    s_cmp_eq_u64 s[4:5], 0
    s_cselect_b32 s71, 16, 0
    s_or_b32 s57, s57, s71
    s_cmp_eq_u64 s[6:7], 0
    s_cselect_b32 s71, 32, 0
    s_or_b32 s57, s57, s71
    s_cmp_eq_u64 s[8:9], 0
    s_cselect_b32 s71, 64, 0
    s_or_b32 s57, s57, s71
    s_cmp_eq_u64 s[10:11], 0
    s_cselect_b32 s71, 128, 0
    s_or_b32 s57, s57, s71
    v_mul_f32 v10, s96, v64
    v_mul_f32 v11, s96, v66
    s_and_b32 s71, s57, s58
    s_bfe_u32 s71, s71, 262148
    s_cmp_lg_u32 s71, 15
    s_cbranch_scc1 GB_22
    v_fmac_f32 v10, s97, v68
    v_fmac_f32 v11, s97, v70
    v_fmac_f32 v10, s98, v72
    v_fmac_f32 v11, s98, v74
    v_fmac_f32 v10, s99, v76
    v_fmac_f32 v11, s99, v78
    v_cvt_pk_bf16_f32 v10, v10, v11
    ds_write_b32 v13, v10 offset:23824
    s_bitset1_b32 s74, 1
GB_22:
    s_bitcmp1_b32 s74, 2
    s_cbranch_scc1 GB_23
    v_xor_b32 v32, s52, v81
    v_xor_b32 v33, s52, v83
    v_xor_b32 v34, s52, v85
    v_xor_b32 v35, s52, v87
    v_xor_b32 v36, s52, v89
    v_xor_b32 v37, s52, v91
    v_xor_b32 v38, s52, v93
    v_xor_b32 v39, s52, v95
    v_or_b32 v32, v32, v33
    v_or_b32 v34, v34, v35
    v_or_b32 v36, v36, v37
    v_or_b32 v38, v38, v39
    v_cmp_ne_u32 s[4:5], 0, v32
    v_cmp_ne_u32 s[6:7], 0, v34
    v_cmp_ne_u32 s[8:9], 0, v36
    v_cmp_ne_u32 s[10:11], 0, v38
    v_readlane_b32 s96, v12, 8
    v_readlane_b32 s97, v12, 9
    v_readlane_b32 s98, v12, 10
    v_readlane_b32 s99, v12, 11
    s_cmp_eq_u64 s[4:5], 0
    s_cselect_b32 s71, 256, 0
    s_or_b32 s57, s57, s71
    s_cmp_eq_u64 s[6:7], 0
    s_cselect_b32 s71, 512, 0
    s_or_b32 s57, s57, s71
    s_cmp_eq_u64 s[8:9], 0
    s_cselect_b32 s71, 1024, 0
    s_or_b32 s57, s57, s71
    s_cmp_eq_u64 s[10:11], 0
    s_cselect_b32 s71, 2048, 0
    s_or_b32 s57, s57, s71
    v_mul_f32 v10, s96, v80
    v_mul_f32 v11, s96, v82
    s_and_b32 s71, s57, s58
    s_bfe_u32 s71, s71, 262152
    s_cmp_lg_u32 s71, 15
    s_cbranch_scc1 GB_23
    v_fmac_f32 v10, s97, v84
    v_fmac_f32 v11, s97, v86
    v_fmac_f32 v10, s98, v88
    v_fmac_f32 v11, s98, v90
    v_fmac_f32 v10, s99, v92
    v_fmac_f32 v11, s99, v94
    v_cvt_pk_bf16_f32 v10, v10, v11
    ds_write_b32 v13, v10 offset:24096
    s_bitset1_b32 s74, 2
GB_23:
    s_sub_u32 s62, s62, 1
    s_cmp_eq_u32 s62, 0
    s_cbranch_scc1 M_end
    s_cmp_lg_u32 s74, 7
    s_cbranch_scc1 G_17
    v_mov_b32 v8, 25876
    v_mov_b32 v9, 1
    ds_write_b32 v8, v9
    s_branch M_fin
M_w3:
    s_cmp_ge_u32 s2, 224
    s_cbranch_scc1 M_fin
    v_mov_b32 v8, 25856
    s_mov_b32 s75, 2097152
W_24:
    ds_read_b128 v[32:35], v8 offset:0
    s_sub_u32 s75, s75, 1
    s_cmp_eq_u32 s75, 0
    s_cbranch_scc1 M_end
    s_waitcnt lgkmcnt(0)
    v_readfirstlane_b32 s79, v32
    v_readfirstlane_b32 s52, v33
    s_cmp_lg_u32 s79, 0
    s_cbranch_scc1 K_25
    s_sleep 1
    s_branch W_24
K_25:
    s_barrier
    s_and_b32 s76, s2, 31
    s_mul_i32 s76, s76, 114688
    s_lshr_b32 s71, s2, 5
    s_lshl_b32 s71, s71, 7
    s_add_u32 s76, s76, s71
    v_mul_u32_u24 v15, 7168, v47
    v_lshl_add_u32 v15, v46, 3, v15
    s_add_u32 s71, s76, 0
    buffer_load_dwordx2 v[48:49], v15, s[40:43], s71 offen offset:0 nt
    buffer_load_dwordx2 v[50:51], v15, s[40:43], s71 offen offset:896 nt
    buffer_load_dwordx2 v[52:53], v15, s[40:43], s71 offen offset:1792 nt
    buffer_load_dwordx2 v[54:55], v15, s[40:43], s71 offen offset:2688 nt
    s_add_u32 s71, s76, 3584
    buffer_load_dwordx2 v[56:57], v15, s[40:43], s71 offen offset:0 nt
    buffer_load_dwordx2 v[58:59], v15, s[40:43], s71 offen offset:896 nt
    buffer_load_dwordx2 v[60:61], v15, s[40:43], s71 offen offset:1792 nt
    buffer_load_dwordx2 v[62:63], v15, s[40:43], s71 offen offset:2688 nt
    s_add_u32 s71, s76, 28672
    buffer_load_dwordx2 v[64:65], v15, s[40:43], s71 offen offset:0 nt
    buffer_load_dwordx2 v[66:67], v15, s[40:43], s71 offen offset:896 nt
    buffer_load_dwordx2 v[68:69], v15, s[40:43], s71 offen offset:1792 nt
    buffer_load_dwordx2 v[70:71], v15, s[40:43], s71 offen offset:2688 nt
    s_add_u32 s71, s76, 32256
    buffer_load_dwordx2 v[72:73], v15, s[40:43], s71 offen offset:0 nt
    buffer_load_dwordx2 v[74:75], v15, s[40:43], s71 offen offset:896 nt
    buffer_load_dwordx2 v[76:77], v15, s[40:43], s71 offen offset:1792 nt
    buffer_load_dwordx2 v[78:79], v15, s[40:43], s71 offen offset:2688 nt
    s_add_u32 s71, s76, 57344
    buffer_load_dwordx2 v[80:81], v15, s[40:43], s71 offen offset:0 nt
    buffer_load_dwordx2 v[82:83], v15, s[40:43], s71 offen offset:896 nt
    buffer_load_dwordx2 v[84:85], v15, s[40:43], s71 offen offset:1792 nt
    buffer_load_dwordx2 v[86:87], v15, s[40:43], s71 offen offset:2688 nt
    s_add_u32 s71, s76, 60928
    buffer_load_dwordx2 v[88:89], v15, s[40:43], s71 offen offset:0 nt
    buffer_load_dwordx2 v[90:91], v15, s[40:43], s71 offen offset:896 nt
    buffer_load_dwordx2 v[92:93], v15, s[40:43], s71 offen offset:1792 nt
    buffer_load_dwordx2 v[94:95], v15, s[40:43], s71 offen offset:2688 nt
    s_add_u32 s71, s76, 86016
    buffer_load_dwordx2 v[96:97], v15, s[40:43], s71 offen offset:0 nt
    buffer_load_dwordx2 v[98:99], v15, s[40:43], s71 offen offset:896 nt
    buffer_load_dwordx2 v[100:101], v15, s[40:43], s71 offen offset:1792 nt
    buffer_load_dwordx2 v[102:103], v15, s[40:43], s71 offen offset:2688 nt
    s_add_u32 s71, s76, 89600
    buffer_load_dwordx2 v[104:105], v15, s[40:43], s71 offen offset:0 nt
    buffer_load_dwordx2 v[106:107], v15, s[40:43], s71 offen offset:896 nt
    buffer_load_dwordx2 v[108:109], v15, s[40:43], s71 offen offset:1792 nt
    buffer_load_dwordx2 v[110:111], v15, s[40:43], s71 offen offset:2688 nt
    s_waitcnt vmcnt(24)
    v_perm_b32 v16, v50, v48, s55
    v_perm_b32 v20, v50, v48, s56
    v_perm_b32 v17, v54, v52, s55
    v_perm_b32 v21, v54, v52, s56
    v_perm_b32 v18, v58, v56, s55
    v_perm_b32 v22, v58, v56, s56
    v_perm_b32 v19, v62, v60, s55
    v_perm_b32 v23, v62, v60, s56
    v_perm_b32 v24, v51, v49, s55
    v_perm_b32 v28, v51, v49, s56
    v_perm_b32 v25, v55, v53, s55
    v_perm_b32 v29, v55, v53, s56
    v_perm_b32 v26, v59, v57, s55
    v_perm_b32 v30, v59, v57, s56
    v_perm_b32 v27, v63, v61, s55
    v_perm_b32 v31, v63, v61, s56
    v_accvgpr_write_b32 a0, v16
    v_accvgpr_write_b32 a1, v17
    v_accvgpr_write_b32 a2, v18
    v_accvgpr_write_b32 a3, v19
    v_accvgpr_write_b32 a4, v20
    v_accvgpr_write_b32 a5, v21
    v_accvgpr_write_b32 a6, v22
    v_accvgpr_write_b32 a7, v23
    v_accvgpr_write_b32 a8, v24
    v_accvgpr_write_b32 a9, v25
    v_accvgpr_write_b32 a10, v26
    v_accvgpr_write_b32 a11, v27
    v_accvgpr_write_b32 a12, v28
    v_accvgpr_write_b32 a13, v29
    v_accvgpr_write_b32 a14, v30
    v_accvgpr_write_b32 a15, v31
    s_waitcnt vmcnt(16)
    v_perm_b32 v16, v66, v64, s55
    v_perm_b32 v20, v66, v64, s56
    v_perm_b32 v17, v70, v68, s55
    v_perm_b32 v21, v70, v68, s56
    v_perm_b32 v18, v74, v72, s55
    v_perm_b32 v22, v74, v72, s56
    v_perm_b32 v19, v78, v76, s55
    v_perm_b32 v23, v78, v76, s56
    v_perm_b32 v24, v67, v65, s55
    v_perm_b32 v28, v67, v65, s56
    v_perm_b32 v25, v71, v69, s55
    v_perm_b32 v29, v71, v69, s56
    v_perm_b32 v26, v75, v73, s55
    v_perm_b32 v30, v75, v73, s56
    v_perm_b32 v27, v79, v77, s55
    v_perm_b32 v31, v79, v77, s56
    v_accvgpr_write_b32 a16, v16
    v_accvgpr_write_b32 a17, v17
    v_accvgpr_write_b32 a18, v18
    v_accvgpr_write_b32 a19, v19
    v_accvgpr_write_b32 a20, v20
    v_accvgpr_write_b32 a21, v21
    v_accvgpr_write_b32 a22, v22
    v_accvgpr_write_b32 a23, v23
    v_accvgpr_write_b32 a24, v24
    v_accvgpr_write_b32 a25, v25
    v_accvgpr_write_b32 a26, v26
    v_accvgpr_write_b32 a27, v27
    v_accvgpr_write_b32 a28, v28
    v_accvgpr_write_b32 a29, v29
    v_accvgpr_write_b32 a30, v30
    v_accvgpr_write_b32 a31, v31
    s_waitcnt vmcnt(8)
    v_perm_b32 v16, v82, v80, s55
    v_perm_b32 v20, v82, v80, s56
    v_perm_b32 v17, v86, v84, s55
    v_perm_b32 v21, v86, v84, s56
    v_perm_b32 v18, v90, v88, s55
    v_perm_b32 v22, v90, v88, s56
    v_perm_b32 v19, v94, v92, s55
    v_perm_b32 v23, v94, v92, s56
    v_perm_b32 v24, v83, v81, s55
    v_perm_b32 v28, v83, v81, s56
    v_perm_b32 v25, v87, v85, s55
    v_perm_b32 v29, v87, v85, s56
    v_perm_b32 v26, v91, v89, s55
    v_perm_b32 v30, v91, v89, s56
    v_perm_b32 v27, v95, v93, s55
    v_perm_b32 v31, v95, v93, s56
    v_accvgpr_write_b32 a32, v16
    v_accvgpr_write_b32 a33, v17
    v_accvgpr_write_b32 a34, v18
    v_accvgpr_write_b32 a35, v19
    v_accvgpr_write_b32 a36, v20
    v_accvgpr_write_b32 a37, v21
    v_accvgpr_write_b32 a38, v22
    v_accvgpr_write_b32 a39, v23
    v_accvgpr_write_b32 a40, v24
    v_accvgpr_write_b32 a41, v25
    v_accvgpr_write_b32 a42, v26
    v_accvgpr_write_b32 a43, v27
    v_accvgpr_write_b32 a44, v28
    v_accvgpr_write_b32 a45, v29
    v_accvgpr_write_b32 a46, v30
    v_accvgpr_write_b32 a47, v31
    s_waitcnt vmcnt(0)
    v_perm_b32 v16, v98, v96, s55
    v_perm_b32 v20, v98, v96, s56
    v_perm_b32 v17, v102, v100, s55
    v_perm_b32 v21, v102, v100, s56
    v_perm_b32 v18, v106, v104, s55
    v_perm_b32 v22, v106, v104, s56
    v_perm_b32 v19, v110, v108, s55
    v_perm_b32 v23, v110, v108, s56
    v_perm_b32 v24, v99, v97, s55
    v_perm_b32 v28, v99, v97, s56
    v_perm_b32 v25, v103, v101, s55
    v_perm_b32 v29, v103, v101, s56
    v_perm_b32 v26, v107, v105, s55
    v_perm_b32 v30, v107, v105, s56
    v_perm_b32 v27, v111, v109, s55
    v_perm_b32 v31, v111, v109, s56
    v_accvgpr_write_b32 a48, v16
    v_accvgpr_write_b32 a49, v17
    v_accvgpr_write_b32 a50, v18
    v_accvgpr_write_b32 a51, v19
    v_accvgpr_write_b32 a52, v20
    v_accvgpr_write_b32 a53, v21
    v_accvgpr_write_b32 a54, v22
    v_accvgpr_write_b32 a55, v23
    v_accvgpr_write_b32 a56, v24
    v_accvgpr_write_b32 a57, v25
    v_accvgpr_write_b32 a58, v26
    v_accvgpr_write_b32 a59, v27
    v_accvgpr_write_b32 a60, v28
    v_accvgpr_write_b32 a61, v29
    v_accvgpr_write_b32 a62, v30
    v_accvgpr_write_b32 a63, v31
    v_and_b32 v8, 1, v47
    v_and_b32 v9, 2, v47
    v_cmp_ne_u32 s[64:65], 0, v8
    v_cmp_ne_u32 s[66:67], 0, v9
    v_and_b32 v44, 7, v46
    v_mul_u32_u24 v44, 272, v44
    v_lshl_add_u32 v44, v47, 4, v44
    v_lshlrev_b32 v45, 4, v0
    s_lshl_b32 s77, s2, 12
    s_add_u32 s77, s77, 1572864
    v_mov_b32 v113, s52
    v_mov_b32 v115, s52
    v_mov_b32 v117, s52
    v_mov_b32 v119, s52
    v_mov_b32 v121, s52
    v_mov_b32 v123, s52
    v_mov_b32 v125, s52
    v_mov_b32 v127, s52
    s_lshr_b32 s71, s2, 5
    s_lshl_b32 s51, s71, 7
    s_lshl_b32 s48, s71, 17
    s_and_b32 s71, s2, 31
    s_lshl_b32 s76, s71, 7
    s_add_u32 s48, s48, s76
    s_add_u32 s48, s48, 1572864
    s_add_u32 s49, s48, 16384
    s_add_u32 s50, s48, 32768
    s_add_u32 s61, s48, 49152
    s_add_u32 s12, s48, 65536
    s_add_u32 s13, s48, 81920
    s_add_u32 s14, s48, 98304
    s_add_u32 s15, s48, 114688
    v_lshlrev_b32 v208, 12, v47
    v_lshl_add_u32 v208, v46, 3, v208
    s_bitcmp1_b32 s71, 4
    s_cselect_b32 s76, 896, 0
    s_add_u32 s51, s51, s76
    s_bitcmp1_b32 s71, 3
    s_cselect_b32 s76, 4, 0
    s_add_u32 s51, s51, s76
    s_bitcmp1_b32 s71, 2
    s_cselect_b32 s76, 1792, 0
    s_add_u32 s51, s51, s76
    s_bitcmp1_b32 s71, 1
    s_cselect_b32 s76, 3584, 0
    s_add_u32 s51, s51, s76
    s_bitcmp1_b32 s71, 0
    s_cselect_b32 s76, 64, 0
    s_add_u32 s51, s51, s76
    v_lshrrev_b32 v209, 1, v46
    v_lshlrev_b32 v209, 3, v209
    v_and_b32 v210, 1, v46
    v_lshl_add_u32 v209, v210, 1, v209
    s_load_dword s53, s[18:19], 0
    s_waitcnt lgkmcnt(0)
    s_and_b32 s70, s2, 28
    s_add_u32 s70, s70, 192
    s_and_b32 s71, s2, 3
    s_lshl_b32 s72, s70, 12
    s_and_b32 s76, s71, 1
    s_lshl_b32 s76, s76, 9
    s_add_u32 s72, s72, s76
    s_lshr_b32 s76, s71, 1
    s_lshl_b32 s76, s76, 8
    s_add_u32 s72, s72, s76
    s_add_u32 s72, s72, 262144
    s_lshl_b32 s73, s70, 7
    s_lshr_b32 s71, s71, 1
    s_lshl_b32 s71, s71, 4
    s_add_u32 s73, s73, s71
    s_add_u32 s73, s73, 1310720
    v_lshlrev_b32 v14, 10, v47
    v_lshl_add_u32 v14, v46, 4, v14
    v_min_u32 v15, 7, v46
    v_lshrrev_b32 v13, 2, v15
    v_lshlrev_b32 v13, 12, v13
    v_and_b32 v15, 3, v15
    v_lshl_add_u32 v15, v15, 7, v13
    v_lshlrev_b32 v13, 4, v46
    v_lshl_add_u32 v13, v47, 2, v13
    s_not_b32 s71, s52
    v_mov_b32 v49, s71
    v_mov_b32 v53, s71
    v_mov_b32 v57, s71
    v_mov_b32 v61, s71
    v_mov_b32 v65, s71
    v_mov_b32 v69, s71
    v_mov_b32 v73, s71
    v_mov_b32 v77, s71
    v_mov_b32 v176, 0
    v_mov_b32 v177, s71
    v_mov_b32 v178, 1.0
    v_mov_b32 v179, s71
    s_mov_b32 s74, 0
    s_mov_b32 s57, 0
    s_mov_b32 s58, 0
    v_mov_b32 v8, 25856
    s_mov_b32 s75, 2097152
W_26:
    ds_read_b128 v[32:35], v8 offset:16
    s_sub_u32 s75, s75, 1
    s_cmp_eq_u32 s75, 0
    s_cbranch_scc1 M_end
    s_waitcnt lgkmcnt(0)
    v_readfirstlane_b32 s79, v32
    s_nop 0
    s_cmp_lg_u32 s79, 0
    s_cbranch_scc1 K_27
    s_sleep 1
    s_branch W_26
K_27:
G_28:
    s_andn2_b32 s71, 255, s58
    s_mov_b32 exec_lo, s71
    s_mov_b32 exec_hi, 0
    buffer_load_dwordx4 v[176:179], v15, s[28:31], s73 offen sc1
    s_mov_b64 exec, -1
    s_bcnt1_i32_b32 s71, s71
    s_cmp_le_u32 s71, 16
    s_cselect_b32 s59, 255, s58
    s_andn2_b32 s59, s59, s57
    s_bfe_u32 s71, s59, 262144
    s_cbranch_scc0 GS_29
    s_bitcmp1_b32 s59, 0
    s_cselect_b64 exec, -1, 0
    s_add_u32 s71, s72, 0
    buffer_load_dwordx4 v[48:51], v14, s[28:31], s71 offen sc1
    s_bitcmp1_b32 s59, 1
    s_cselect_b64 exec, -1, 0
    s_add_u32 s71, s72, 4096
    buffer_load_dwordx4 v[52:55], v14, s[28:31], s71 offen sc1
    s_bitcmp1_b32 s59, 2
    s_cselect_b64 exec, -1, 0
    s_add_u32 s71, s72, 8192
    buffer_load_dwordx4 v[56:59], v14, s[28:31], s71 offen sc1
    s_bitcmp1_b32 s59, 3
    s_cselect_b64 exec, -1, 0
    s_add_u32 s71, s72, 12288
    buffer_load_dwordx4 v[60:63], v14, s[28:31], s71 offen sc1
    s_mov_b64 exec, -1
GS_29:
    s_bfe_u32 s71, s59, 262148
    s_cbranch_scc0 GS_30
    s_bitcmp1_b32 s59, 4
    s_cselect_b64 exec, -1, 0
    s_add_u32 s71, s72, 131072
    buffer_load_dwordx4 v[64:67], v14, s[28:31], s71 offen sc1
    s_bitcmp1_b32 s59, 5
    s_cselect_b64 exec, -1, 0
    s_add_u32 s71, s72, 135168
    buffer_load_dwordx4 v[68:71], v14, s[28:31], s71 offen sc1
    s_bitcmp1_b32 s59, 6
    s_cselect_b64 exec, -1, 0
    s_add_u32 s71, s72, 139264
    buffer_load_dwordx4 v[72:75], v14, s[28:31], s71 offen sc1
    s_bitcmp1_b32 s59, 7
    s_cselect_b64 exec, -1, 0
    s_add_u32 s71, s72, 143360
    buffer_load_dwordx4 v[76:79], v14, s[28:31], s71 offen sc1
    s_mov_b64 exec, -1
GS_30:
    s_waitcnt vmcnt(0)
    v_xor_b32 v9, s52, v177
    v_xor_b32 v10, s52, v179
    v_or_b32 v9, v9, v10
    v_cmp_eq_u32 vcc, 0, v9
    v_max_f32_dpp v9, v176, v176 quad_perm:[1,0,3,2] row_mask:0xf bank_mask:0xf
    s_and_b32 s58, vcc_lo, 255
    s_nop 0
    v_max_f32_dpp v9, v9, v9 quad_perm:[2,3,0,1] row_mask:0xf bank_mask:0xf
    v_sub_f32 v9, v176, v9
    v_exp_f32 v9, v9
    s_nop 0
    v_mul_f32 v10, v9, v178
    s_nop 1
    v_add_f32_dpp v10, v10, v10 quad_perm:[1,0,3,2] row_mask:0xf bank_mask:0xf
    s_nop 1
    v_add_f32_dpp v10, v10, v10 quad_perm:[2,3,0,1] row_mask:0xf bank_mask:0xf
    v_rcp_f32 v10, v10
    s_nop 0
    v_mul_f32 v12, v9, v10
    s_bitcmp1_b32 s74, 0
    s_cbranch_scc1 GB_31
    v_xor_b32 v32, s52, v49
    v_xor_b32 v33, s52, v51
    v_xor_b32 v34, s52, v53
    v_xor_b32 v35, s52, v55
    v_xor_b32 v36, s52, v57
    v_xor_b32 v37, s52, v59
    v_xor_b32 v38, s52, v61
    v_xor_b32 v39, s52, v63
    v_or_b32 v32, v32, v33
    v_or_b32 v34, v34, v35
    v_or_b32 v36, v36, v37
    v_or_b32 v38, v38, v39
    v_cmp_ne_u32 s[4:5], 0, v32
    v_cmp_ne_u32 s[6:7], 0, v34
    v_cmp_ne_u32 s[8:9], 0, v36
    v_cmp_ne_u32 s[10:11], 0, v38
    v_readlane_b32 s96, v12, 0
    v_readlane_b32 s97, v12, 1
    v_readlane_b32 s98, v12, 2
    v_readlane_b32 s99, v12, 3
    s_cmp_eq_u64 s[4:5], 0
    s_cselect_b32 s71, 1, 0
    s_or_b32 s57, s57, s71
    s_cmp_eq_u64 s[6:7], 0
    s_cselect_b32 s71, 2, 0
    s_or_b32 s57, s57, s71
    s_cmp_eq_u64 s[8:9], 0
    s_cselect_b32 s71, 4, 0
    s_or_b32 s57, s57, s71
    s_cmp_eq_u64 s[10:11], 0
    s_cselect_b32 s71, 8, 0
    s_or_b32 s57, s57, s71
    v_mul_f32 v10, s96, v48
    v_mul_f32 v11, s96, v50
    s_and_b32 s71, s57, s58
    s_bfe_u32 s71, s71, 262144
    s_cmp_lg_u32 s71, 15
    s_cbranch_scc1 GB_31
    v_fmac_f32 v10, s97, v52
    v_fmac_f32 v11, s97, v54
    v_fmac_f32 v10, s98, v56
    v_fmac_f32 v11, s98, v58
    v_fmac_f32 v10, s99, v60
    v_fmac_f32 v11, s99, v62
    v_cvt_pk_bf16_f32 v10, v10, v11
    ds_write_b32 v13, v10 offset:25184
    s_bitset1_b32 s74, 0
GB_31:
    s_bitcmp1_b32 s74, 1
    s_cbranch_scc1 GB_32
    v_xor_b32 v32, s52, v65
    v_xor_b32 v33, s52, v67
    v_xor_b32 v34, s52, v69
    v_xor_b32 v35, s52, v71
    v_xor_b32 v36, s52, v73
    v_xor_b32 v37, s52, v75
    v_xor_b32 v38, s52, v77
    v_xor_b32 v39, s52, v79
    v_or_b32 v32, v32, v33
    v_or_b32 v34, v34, v35
    v_or_b32 v36, v36, v37
    v_or_b32 v38, v38, v39
    v_cmp_ne_u32 s[4:5], 0, v32
    v_cmp_ne_u32 s[6:7], 0, v34
    v_cmp_ne_u32 s[8:9], 0, v36
    v_cmp_ne_u32 s[10:11], 0, v38
    v_readlane_b32 s96, v12, 4
    v_readlane_b32 s97, v12, 5
    v_readlane_b32 s98, v12, 6
    v_readlane_b32 s99, v12, 7
    s_cmp_eq_u64 s[4:5], 0
    s_cselect_b32 s71, 16, 0
    s_or_b32 s57, s57, s71
    s_cmp_eq_u64 s[6:7], 0
    s_cselect_b32 s71, 32, 0
    s_or_b32 s57, s57, s71
    s_cmp_eq_u64 s[8:9], 0
    s_cselect_b32 s71, 64, 0
    s_or_b32 s57, s57, s71
    s_cmp_eq_u64 s[10:11], 0
    s_cselect_b32 s71, 128, 0
    s_or_b32 s57, s57, s71
    v_mul_f32 v10, s96, v64
    v_mul_f32 v11, s96, v66
    s_and_b32 s71, s57, s58
    s_bfe_u32 s71, s71, 262148
    s_cmp_lg_u32 s71, 15
    s_cbranch_scc1 GB_32
    v_fmac_f32 v10, s97, v68
    v_fmac_f32 v11, s97, v70
    v_fmac_f32 v10, s98, v72
    v_fmac_f32 v11, s98, v74
    v_fmac_f32 v10, s99, v76
    v_fmac_f32 v11, s99, v78
    v_cvt_pk_bf16_f32 v10, v10, v11
    ds_write_b32 v13, v10 offset:25456
    s_bitset1_b32 s74, 1
GB_32:
    s_sub_u32 s62, s62, 1
    s_cmp_eq_u32 s62, 0
    s_cbranch_scc1 M_end
    s_cmp_lg_u32 s74, 3
    s_cbranch_scc1 G_28
    v_mov_b32 v8, 25856
    s_mov_b32 s75, 2097152
W_33:
    ds_read_b128 v[32:35], v8 offset:16
    s_sub_u32 s75, s75, 1
    s_cmp_eq_u32 s75, 0
    s_cbranch_scc1 M_end
    s_waitcnt lgkmcnt(0)
    v_readfirstlane_b32 s79, v33
    v_readfirstlane_b32 s71, v34
    s_nop 0
    s_and_b32 s79, s79, s71
    s_cmp_lg_u32 s79, 0
    s_cbranch_scc1 K_34
    s_sleep 1
    s_branch W_33
K_34:
    ds_read_b128 v[176:179], v44 offset:23552
    ds_read_b128 v[180:183], v44 offset:23616
    ds_read_b128 v[184:187], v44 offset:23680
    ds_read_b128 v[188:191], v44 offset:23744
    s_waitcnt lgkmcnt(3)
    v_mfma_f32_16x16x32_bf16 v[192:195], v[176:179], a[0:3], 0
    v_mfma_f32_16x16x32_bf16 v[196:199], v[176:179], a[4:7], 0
    v_mfma_f32_16x16x32_bf16 v[200:203], v[176:179], a[8:11], 0
    v_mfma_f32_16x16x32_bf16 v[204:207], v[176:179], a[12:15], 0
    s_waitcnt lgkmcnt(2)
    v_mfma_f32_16x16x32_bf16 v[192:195], v[180:183], a[16:19], v[192:195]
    v_mfma_f32_16x16x32_bf16 v[196:199], v[180:183], a[20:23], v[196:199]
    v_mfma_f32_16x16x32_bf16 v[200:203], v[180:183], a[24:27], v[200:203]
    v_mfma_f32_16x16x32_bf16 v[204:207], v[180:183], a[28:31], v[204:207]
    s_waitcnt lgkmcnt(1)
    v_mfma_f32_16x16x32_bf16 v[192:195], v[184:187], a[32:35], v[192:195]
    v_mfma_f32_16x16x32_bf16 v[196:199], v[184:187], a[36:39], v[196:199]
    v_mfma_f32_16x16x32_bf16 v[200:203], v[184:187], a[40:43], v[200:203]
    v_mfma_f32_16x16x32_bf16 v[204:207], v[184:187], a[44:47], v[204:207]
    s_waitcnt lgkmcnt(0)
    v_mfma_f32_16x16x32_bf16 v[192:195], v[188:191], a[48:51], v[192:195]
    v_mfma_f32_16x16x32_bf16 v[196:199], v[188:191], a[52:55], v[196:199]
    v_mfma_f32_16x16x32_bf16 v[200:203], v[188:191], a[56:59], v[200:203]
    v_mfma_f32_16x16x32_bf16 v[204:207], v[188:191], a[60:63], v[204:207]
    s_nop 4
    v_cndmask_b32 v112, v192, v194, s[66:67]
    v_cndmask_b32 v120, v193, v195, s[66:67]
    v_cndmask_b32 v114, v196, v198, s[66:67]
    v_cndmask_b32 v122, v197, v199, s[66:67]
    buffer_store_dwordx4 v[112:115], v45, s[28:31], s77 offen offset:0 sc1
    buffer_store_dwordx4 v[120:123], v45, s[28:31], s77 offen offset:2048 sc1
    v_cndmask_b32 v116, v200, v202, s[66:67]
    v_cndmask_b32 v124, v201, v203, s[66:67]
    v_cndmask_b32 v118, v204, v206, s[66:67]
    v_cndmask_b32 v126, v205, v207, s[66:67]
    buffer_store_dwordx4 v[116:119], v45, s[28:31], s77 offen offset:1024 sc1
    buffer_store_dwordx4 v[124:127], v45, s[28:31], s77 offen offset:3072 sc1
    s_not_b32 s71, s52
    v_mov_b32 v49, s71
    v_mov_b32 v51, s71
    v_mov_b32 v53, s71
    v_mov_b32 v55, s71
    v_mov_b32 v57, s71
    v_mov_b32 v59, s71
    v_mov_b32 v61, s71
    v_mov_b32 v63, s71
    s_mov_b32 s57, 0
M_p2:
    s_bitcmp0_b32 s57, 0
    s_cselect_b64 exec, -1, 0
    buffer_load_dwordx2 v[48:49], v208, s[28:31], s48 offen sc1
    s_bitcmp0_b32 s57, 1
    s_cselect_b64 exec, -1, 0
    buffer_load_dwordx2 v[50:51], v208, s[28:31], s49 offen sc1
    s_bitcmp0_b32 s57, 2
    s_cselect_b64 exec, -1, 0
    buffer_load_dwordx2 v[52:53], v208, s[28:31], s50 offen sc1
    s_bitcmp0_b32 s57, 3
    s_cselect_b64 exec, -1, 0
    buffer_load_dwordx2 v[54:55], v208, s[28:31], s61 offen sc1
    s_bitcmp0_b32 s57, 4
    s_cselect_b64 exec, -1, 0
    buffer_load_dwordx2 v[56:57], v208, s[28:31], s12 offen sc1
    s_bitcmp0_b32 s57, 5
    s_cselect_b64 exec, -1, 0
    buffer_load_dwordx2 v[58:59], v208, s[28:31], s13 offen sc1
    s_bitcmp0_b32 s57, 6
    s_cselect_b64 exec, -1, 0
    buffer_load_dwordx2 v[60:61], v208, s[28:31], s14 offen sc1
    s_bitcmp0_b32 s57, 7
    s_cselect_b64 exec, -1, 0
    buffer_load_dwordx2 v[62:63], v208, s[28:31], s15 offen sc1
    s_mov_b64 exec, -1
    s_sub_u32 s62, s62, 1
    s_cmp_eq_u32 s62, 0
    s_cbranch_scc1 M_end
    s_waitcnt vmcnt(0)
    v_xor_b32 v32, s52, v49
    v_xor_b32 v33, s52, v51
    v_xor_b32 v34, s52, v53
    v_xor_b32 v35, s52, v55
    v_xor_b32 v36, s52, v57
    v_xor_b32 v37, s52, v59
    v_xor_b32 v38, s52, v61
    v_xor_b32 v39, s52, v63
    v_or3_b32 v9, v32, v33, v34
    v_or3_b32 v10, v35, v36, v37
    v_or3_b32 v9, v9, v38, v39
    v_or_b32 v9, v9, v10
    v_cmp_ne_u32 vcc, 0, v9
    v_add_f32 v16, v48, v50
    v_add_f32 v17, v52, v54
    v_add_f32 v18, v56, v58
    v_add_f32 v19, v60, v62
    v_add_f32 v16, v16, v17
    v_add_f32 v18, v18, v19
    v_add_f32 v11, v16, v18
    s_cbranch_vccz M_p2ok
    v_cmp_ne_u32 s[4:5], 0, v32
    v_cmp_ne_u32 s[6:7], 0, v33
    v_cmp_ne_u32 s[8:9], 0, v34
    v_cmp_ne_u32 s[10:11], 0, v35
    s_nop 0
    s_cmp_eq_u64 s[4:5], 0
    s_cselect_b32 s71, 1, 0
    s_or_b32 s57, s57, s71
    s_cmp_eq_u64 s[6:7], 0
    s_cselect_b32 s71, 2, 0
    s_or_b32 s57, s57, s71
    s_cmp_eq_u64 s[8:9], 0
    s_cselect_b32 s71, 4, 0
    s_or_b32 s57, s57, s71
    s_cmp_eq_u64 s[10:11], 0
    s_cselect_b32 s71, 8, 0
    s_or_b32 s57, s57, s71
    v_cmp_ne_u32 s[4:5], 0, v36
    v_cmp_ne_u32 s[6:7], 0, v37
    v_cmp_ne_u32 s[8:9], 0, v38
    v_cmp_ne_u32 s[10:11], 0, v39
    s_nop 0
    s_cmp_eq_u64 s[4:5], 0
    s_cselect_b32 s71, 16, 0
    s_or_b32 s57, s57, s71
    s_cmp_eq_u64 s[6:7], 0
    s_cselect_b32 s71, 32, 0
    s_or_b32 s57, s57, s71
    s_cmp_eq_u64 s[8:9], 0
    s_cselect_b32 s71, 64, 0
    s_or_b32 s57, s57, s71
    s_cmp_eq_u64 s[10:11], 0
    s_cselect_b32 s71, 128, 0
    s_or_b32 s57, s57, s71
    s_branch M_p2
M_p2ok:
    v_mov_b32 v12, v11
    s_nop 1
    v_permlane16_swap_b32 v11, v12
    s_nop 0
    v_add_f32 v11, v11, v12
    v_mov_b32 v12, v11
    s_nop 1
    v_permlane32_swap_b32 v11, v12
    s_nop 0
    v_add_f32 v11, v11, v12
    v_cvt_pk_bf16_f32 v9, v11, v11
    s_mov_b64 exec, 0xffff
    buffer_store_short v9, v209, s[44:47], s51 offen
    s_mov_b64 exec, 1
    s_cmp_lg_u32 s2, 0
    s_cbranch_scc1 M_nogen
    v_mov_b32 v14, 0
    s_add_u32 s53, s53, 1
    v_mov_b32 v15, s53
    buffer_store_dword v15, v14, s[28:31], 0 offen offset:0 sc1
M_nogen:
    s_mov_b64 exec, -1
    s_branch M_fin
M_w2:
    s_setprio 3
    s_load_dword s53, s[18:19], 0
    s_and_b32 s70, s2, 3
    s_cmp_lg_u32 s70, 0
    s_cbranch_scc1 M_noprod1
    s_bfe_u32 s70, s2, 196610
    s_lshl_b32 s70, s70, 3
    s_lshr_b32 s72, s2, 5
    s_add_u32 s70, s70, s72
    s_lshr_b32 s71, s2, 2
    s_lshl_b32 s71, s71, 8
    s_add_u32 s71, s71, 196608
    v_mov_b32 v9, 0
    s_mov_b64 exec, 1
    buffer_store_dword v9, v9, s[28:31], s71 offen sc1
    s_mov_b64 exec, -1
    s_lshl_b32 s71, s70, 7
    v_lshrrev_b32 v7, 3, v0
    v_lshlrev_b32 v7, 13, v7
    v_and_b32 v8, 7, v0
    v_lshl_add_u32 v7, v8, 4, v7
    v_and_b32 v8, 7, v46
    v_mul_u32_u24 v8, 896, v8
    v_lshl_add_u32 v8, v47, 4, v8
    buffer_load_dwordx4 v[48:51], v8, s[32:35], 0 offen offset:0
    buffer_load_dwordx4 v[52:55], v8, s[32:35], 0 offen offset:64
    buffer_load_dwordx4 v[56:59], v8, s[32:35], 0 offen offset:128
    buffer_load_dwordx4 v[60:63], v8, s[32:35], 0 offen offset:192
    buffer_load_dwordx4 v[64:67], v8, s[32:35], 0 offen offset:256
    buffer_load_dwordx4 v[68:71], v8, s[32:35], 0 offen offset:320
    buffer_load_dwordx4 v[72:75], v8, s[32:35], 0 offen offset:384
    buffer_load_dwordx4 v[76:79], v8, s[32:35], 0 offen offset:448
    buffer_load_dwordx4 v[80:83], v8, s[32:35], 0 offen offset:512
    buffer_load_dwordx4 v[84:87], v8, s[32:35], 0 offen offset:576
    buffer_load_dwordx4 v[88:91], v8, s[32:35], 0 offen offset:640
    buffer_load_dwordx4 v[92:95], v8, s[32:35], 0 offen offset:704
    buffer_load_dwordx4 v[96:99], v8, s[32:35], 0 offen offset:768
    buffer_load_dwordx4 v[100:103], v8, s[32:35], 0 offen offset:832
    s_mov_b32 m0, 27136
    s_add_u32 s73, s71, 0
    buffer_load_dwordx4 v7, s[36:39], s73 offen nt lds
    s_mov_b32 m0, 28160
    s_add_u32 s73, s71, 65536
    buffer_load_dwordx4 v7, s[36:39], s73 offen nt lds
    s_mov_b32 m0, 29184
    s_add_u32 s73, s71, 131072
    buffer_load_dwordx4 v7, s[36:39], s73 offen nt lds
    s_mov_b32 m0, 30208
    s_add_u32 s73, s71, 196608
    buffer_load_dwordx4 v7, s[36:39], s73 offen nt lds
    s_mov_b32 m0, 31232
    s_add_u32 s73, s71, 262144
    buffer_load_dwordx4 v7, s[36:39], s73 offen nt lds
    s_mov_b32 m0, 32256
    s_add_u32 s73, s71, 327680
    buffer_load_dwordx4 v7, s[36:39], s73 offen nt lds
    s_mov_b32 m0, 33280
    s_add_u32 s73, s71, 393216
    buffer_load_dwordx4 v7, s[36:39], s73 offen nt lds
    s_mov_b32 m0, 34304
    s_add_u32 s73, s71, 458752
    buffer_load_dwordx4 v7, s[36:39], s73 offen nt lds
    s_mov_b32 m0, 35328
    s_add_u32 s73, s71, 524288
    buffer_load_dwordx4 v7, s[36:39], s73 offen nt lds
    s_mov_b32 m0, 36352
    s_add_u32 s73, s71, 589824
    buffer_load_dwordx4 v7, s[36:39], s73 offen nt lds
    s_mov_b32 m0, 37376
    s_add_u32 s73, s71, 655360
    buffer_load_dwordx4 v7, s[36:39], s73 offen nt lds
    s_mov_b32 m0, 38400
    s_add_u32 s73, s71, 720896
    buffer_load_dwordx4 v7, s[36:39], s73 offen nt lds
    s_mov_b32 m0, 39424
    s_add_u32 s73, s71, 786432
    buffer_load_dwordx4 v7, s[36:39], s73 offen nt lds
    s_mov_b32 m0, 40448
    s_add_u32 s73, s71, 851968
    buffer_load_dwordx4 v7, s[36:39], s73 offen nt lds
    s_mov_b32 m0, 41472
    s_add_u32 s73, s71, 917504
    buffer_load_dwordx4 v7, s[36:39], s73 offen nt lds
    s_mov_b32 m0, 42496
    s_add_u32 s73, s71, 983040
    buffer_load_dwordx4 v7, s[36:39], s73 offen nt lds
    s_mov_b32 m0, 43520
    s_add_u32 s73, s71, 1048576
    buffer_load_dwordx4 v7, s[36:39], s73 offen nt lds
    s_mov_b32 m0, 44544
    s_add_u32 s73, s71, 1114112
    buffer_load_dwordx4 v7, s[36:39], s73 offen nt lds
    s_mov_b32 m0, 45568
    s_add_u32 s73, s71, 1179648
    buffer_load_dwordx4 v7, s[36:39], s73 offen nt lds
    s_mov_b32 m0, 46592
    s_add_u32 s73, s71, 1245184
    buffer_load_dwordx4 v7, s[36:39], s73 offen nt lds
    s_mov_b32 m0, 47616
    s_add_u32 s73, s71, 1310720
    buffer_load_dwordx4 v7, s[36:39], s73 offen nt lds
    s_mov_b32 m0, 48640
    s_add_u32 s73, s71, 1376256
    buffer_load_dwordx4 v7, s[36:39], s73 offen nt lds
    s_mov_b32 m0, 49664
    s_add_u32 s73, s71, 1441792
    buffer_load_dwordx4 v7, s[36:39], s73 offen nt lds
    s_mov_b32 m0, 50688
    s_add_u32 s73, s71, 1507328
    buffer_load_dwordx4 v7, s[36:39], s73 offen nt lds
    s_mov_b32 m0, 51712
    s_add_u32 s73, s71, 1572864
    buffer_load_dwordx4 v7, s[36:39], s73 offen nt lds
    s_mov_b32 m0, 52736
    s_add_u32 s73, s71, 1638400
    buffer_load_dwordx4 v7, s[36:39], s73 offen nt lds
    s_mov_b32 m0, 53760
    s_add_u32 s73, s71, 1703936
    buffer_load_dwordx4 v7, s[36:39], s73 offen nt lds
    s_mov_b32 m0, 54784
    s_add_u32 s73, s71, 1769472
    buffer_load_dwordx4 v7, s[36:39], s73 offen nt lds
    s_mov_b32 m0, 55808
    s_add_u32 s73, s71, 1835008
    buffer_load_dwordx4 v7, s[36:39], s73 offen nt lds
    s_mov_b32 m0, 56832
    s_add_u32 s73, s71, 1900544
    buffer_load_dwordx4 v7, s[36:39], s73 offen nt lds
    s_mov_b32 m0, 57856
    s_add_u32 s73, s71, 1966080
    buffer_load_dwordx4 v7, s[36:39], s73 offen nt lds
    s_mov_b32 m0, 58880
    s_add_u32 s73, s71, 2031616
    buffer_load_dwordx4 v7, s[36:39], s73 offen nt lds
    s_mov_b32 m0, 59904
    s_add_u32 s73, s71, 2097152
    buffer_load_dwordx4 v7, s[36:39], s73 offen nt lds
    s_mov_b32 m0, 60928
    s_add_u32 s73, s71, 2162688
    buffer_load_dwordx4 v7, s[36:39], s73 offen nt lds
    s_mov_b32 m0, 61952
    s_add_u32 s73, s71, 2228224
    buffer_load_dwordx4 v7, s[36:39], s73 offen nt lds
    s_mov_b32 m0, 62976
    s_add_u32 s73, s71, 2293760
    buffer_load_dwordx4 v7, s[36:39], s73 offen nt lds
    s_mov_b32 m0, 64000
    s_add_u32 s73, s71, 2359296
    buffer_load_dwordx4 v7, s[36:39], s73 offen nt lds
    s_mov_b32 m0, 65024
    s_add_u32 s73, s71, 2424832
    buffer_load_dwordx4 v7, s[36:39], s73 offen nt lds
    s_mov_b32 m0, 66048
    s_add_u32 s73, s71, 2490368
    buffer_load_dwordx4 v7, s[36:39], s73 offen nt lds
    s_mov_b32 m0, 67072
    s_add_u32 s73, s71, 2555904
    buffer_load_dwordx4 v7, s[36:39], s73 offen nt lds
    s_mov_b32 m0, 68096
    s_add_u32 s73, s71, 2621440
    buffer_load_dwordx4 v7, s[36:39], s73 offen nt lds
    s_mov_b32 m0, 69120
    s_add_u32 s73, s71, 2686976
    buffer_load_dwordx4 v7, s[36:39], s73 offen nt lds
    s_mov_b32 m0, 70144
    s_add_u32 s73, s71, 2752512
    buffer_load_dwordx4 v7, s[36:39], s73 offen nt lds
    s_mov_b32 m0, 71168
    s_add_u32 s73, s71, 2818048
    buffer_load_dwordx4 v7, s[36:39], s73 offen nt lds
    s_mov_b32 m0, 72192
    s_add_u32 s73, s71, 2883584
    buffer_load_dwordx4 v7, s[36:39], s73 offen nt lds
    s_mov_b32 m0, 73216
    s_add_u32 s73, s71, 2949120
    buffer_load_dwordx4 v7, s[36:39], s73 offen nt lds
    s_mov_b32 m0, 74240
    s_add_u32 s73, s71, 3014656
    buffer_load_dwordx4 v7, s[36:39], s73 offen nt lds
    s_mov_b32 m0, 75264
    s_add_u32 s73, s71, 3080192
    buffer_load_dwordx4 v7, s[36:39], s73 offen nt lds
    s_mov_b32 m0, 76288
    s_add_u32 s73, s71, 3145728
    buffer_load_dwordx4 v7, s[36:39], s73 offen nt lds
    s_mov_b32 m0, 77312
    s_add_u32 s73, s71, 3211264
    buffer_load_dwordx4 v7, s[36:39], s73 offen nt lds
    s_mov_b32 m0, 78336
    s_add_u32 s73, s71, 3276800
    buffer_load_dwordx4 v7, s[36:39], s73 offen nt lds
    s_mov_b32 m0, 79360
    s_add_u32 s73, s71, 3342336
    buffer_load_dwordx4 v7, s[36:39], s73 offen nt lds
    s_mov_b32 m0, 80384
    s_add_u32 s73, s71, 3407872
    buffer_load_dwordx4 v7, s[36:39], s73 offen nt lds
    s_mov_b32 m0, 81408
    s_add_u32 s73, s71, 3473408
    buffer_load_dwordx4 v7, s[36:39], s73 offen nt lds
    s_mov_b32 m0, 82432
    s_add_u32 s73, s71, 3538944
    buffer_load_dwordx4 v7, s[36:39], s73 offen nt lds
    s_mov_b32 m0, 83456
    s_add_u32 s73, s71, 3604480
    buffer_load_dwordx4 v7, s[36:39], s73 offen nt lds
M_noprod1:
    s_barrier
    s_lshr_b32 s74, s2, 2
    s_lshl_b32 s74, s74, 11
    s_add_u32 s74, s74, 4096
    v_lshlrev_b32 v7, 4, v0
    v_lshlrev_b32 v14, 7, v47
    v_bfe_u32 v11, v46, 2, 1
    v_lshl_add_u32 v14, v11, 6, v14
    v_lshrrev_b32 v11, 3, v46
    v_lshl_add_u32 v14, v11, 5, v14
    v_and_b32 v11, 3, v46
    v_lshl_add_u32 v14, v11, 3, v14
    v_add_u32 v14, 26112, v14
    s_waitcnt lgkmcnt(0)
    s_add_u32 s53, s53, 1
    s_mul_i32 s52, s53, 0x9e3779b1
    s_xor_b32 s52, s52, 0x5bd1e995
    v_mov_b32 v13, s52
    s_getreg_b32 s63, hwreg(HW_REG_XCC_ID, 0, 4)
    s_bfe_u32 s77, s2, 196610
    s_lshl_b32 s77, s77, 8
    s_add_u32 s77, s77, 180224
    s_lshr_b32 s71, s2, 5
    s_lshl_b32 s71, s71, 5
    s_and_b32 s72, s2, 3
    s_lshl_b32 s72, s72, 3
    s_add_u32 s71, s71, s72
    v_mov_b32 v11, s71
    v_mov_b32 v12, s63
    s_mov_b64 exec, 1
    buffer_store_dwordx2 v[12:13], v11, s[28:31], s77 offen sc1
    s_mov_b64 exec, -1
    s_and_b32 s71, s2, 3
    s_cmp_lg_u32 s71, 0
    s_cbranch_scc1 M_noprod2
    v_lshrrev_b32 v9, 2, v46
    v_lshl_add_u32 v9, v47, 3, v9
    v_lshlrev_b32 v9, 7, v9
    v_and_b32 v10, 3, v46
    v_lshl_add_u32 v9, v10, 3, v9
    v_add_u32 v9, 27136, v9
    v_and_b32 v10, 7, v46
    v_lshlrev_b32 v10, 14, v10
    v_lshrrev_b32 v11, 3, v46
    v_cmp_ne_u32 s[64:65], 0, v11
    v_lshl_add_u32 v10, v11, 6, v10
    v_lshl_add_u32 v10, v47, 4, v10
    s_lshl_b32 s71, s70, 8
    s_add_u32 s71, s71, 4096
    v_mov_b32 v17, s52
    v_mov_b32 v19, s52
    v_mov_b32 v21, s52
    v_mov_b32 v23, s52
    s_waitcnt vmcnt(53)
    ds_read_b64_tr_b16 v[112:113], v9 offset:0
    ds_read_b64_tr_b16 v[114:115], v9 offset:512
    ds_read_b64_tr_b16 v[116:117], v9 offset:32
    ds_read_b64_tr_b16 v[118:119], v9 offset:544
    ds_read_b64_tr_b16 v[120:121], v9 offset:64
    ds_read_b64_tr_b16 v[122:123], v9 offset:576
    ds_read_b64_tr_b16 v[124:125], v9 offset:96
    ds_read_b64_tr_b16 v[126:127], v9 offset:608
    s_waitcnt vmcnt(49)
    ds_read_b64_tr_b16 v[128:129], v9 offset:4096
    ds_read_b64_tr_b16 v[130:131], v9 offset:4608
    ds_read_b64_tr_b16 v[132:133], v9 offset:4128
    ds_read_b64_tr_b16 v[134:135], v9 offset:4640
    ds_read_b64_tr_b16 v[136:137], v9 offset:4160
    ds_read_b64_tr_b16 v[138:139], v9 offset:4672
    ds_read_b64_tr_b16 v[140:141], v9 offset:4192
    ds_read_b64_tr_b16 v[142:143], v9 offset:4704
    s_waitcnt lgkmcnt(8)
    v_mfma_f32_16x16x32_bf16 v[176:179], v[112:115], v[48:51], 0
    v_mfma_f32_16x16x32_bf16 v[180:183], v[116:119], v[48:51], 0
    v_mfma_f32_16x16x32_bf16 v[184:187], v[120:123], v[48:51], 0
    v_mfma_f32_16x16x32_bf16 v[188:191], v[124:127], v[48:51], 0
    s_waitcnt vmcnt(45)
    ds_read_b64_tr_b16 v[112:113], v9 offset:8192
    ds_read_b64_tr_b16 v[114:115], v9 offset:8704
    ds_read_b64_tr_b16 v[116:117], v9 offset:8224
    ds_read_b64_tr_b16 v[118:119], v9 offset:8736
    ds_read_b64_tr_b16 v[120:121], v9 offset:8256
    ds_read_b64_tr_b16 v[122:123], v9 offset:8768
    ds_read_b64_tr_b16 v[124:125], v9 offset:8288
    ds_read_b64_tr_b16 v[126:127], v9 offset:8800
    s_waitcnt lgkmcnt(8)
    v_mfma_f32_16x16x32_bf16 v[176:179], v[128:131], v[52:55], v[176:179]
    v_mfma_f32_16x16x32_bf16 v[180:183], v[132:135], v[52:55], v[180:183]
    v_mfma_f32_16x16x32_bf16 v[184:187], v[136:139], v[52:55], v[184:187]
    v_mfma_f32_16x16x32_bf16 v[188:191], v[140:143], v[52:55], v[188:191]
    s_waitcnt vmcnt(41)
    ds_read_b64_tr_b16 v[128:129], v9 offset:12288
    ds_read_b64_tr_b16 v[130:131], v9 offset:12800
    ds_read_b64_tr_b16 v[132:133], v9 offset:12320
    ds_read_b64_tr_b16 v[134:135], v9 offset:12832
    ds_read_b64_tr_b16 v[136:137], v9 offset:12352
    ds_read_b64_tr_b16 v[138:139], v9 offset:12864
    ds_read_b64_tr_b16 v[140:141], v9 offset:12384
    ds_read_b64_tr_b16 v[142:143], v9 offset:12896
    s_waitcnt lgkmcnt(8)
    v_mfma_f32_16x16x32_bf16 v[176:179], v[112:115], v[56:59], v[176:179]
    v_mfma_f32_16x16x32_bf16 v[180:183], v[116:119], v[56:59], v[180:183]
    v_mfma_f32_16x16x32_bf16 v[184:187], v[120:123], v[56:59], v[184:187]
    v_mfma_f32_16x16x32_bf16 v[188:191], v[124:127], v[56:59], v[188:191]
    s_waitcnt vmcnt(37)
    ds_read_b64_tr_b16 v[112:113], v9 offset:16384
    ds_read_b64_tr_b16 v[114:115], v9 offset:16896
    ds_read_b64_tr_b16 v[116:117], v9 offset:16416
    ds_read_b64_tr_b16 v[118:119], v9 offset:16928
    ds_read_b64_tr_b16 v[120:121], v9 offset:16448
    ds_read_b64_tr_b16 v[122:123], v9 offset:16960
    ds_read_b64_tr_b16 v[124:125], v9 offset:16480
    ds_read_b64_tr_b16 v[126:127], v9 offset:16992
    s_waitcnt lgkmcnt(8)
    v_mfma_f32_16x16x32_bf16 v[176:179], v[128:131], v[60:63], v[176:179]
    v_mfma_f32_16x16x32_bf16 v[180:183], v[132:135], v[60:63], v[180:183]
    v_mfma_f32_16x16x32_bf16 v[184:187], v[136:139], v[60:63], v[184:187]
    v_mfma_f32_16x16x32_bf16 v[188:191], v[140:143], v[60:63], v[188:191]
    s_waitcnt vmcnt(33)
    ds_read_b64_tr_b16 v[128:129], v9 offset:20480
    ds_read_b64_tr_b16 v[130:131], v9 offset:20992
    ds_read_b64_tr_b16 v[132:133], v9 offset:20512
    ds_read_b64_tr_b16 v[134:135], v9 offset:21024
    ds_read_b64_tr_b16 v[136:137], v9 offset:20544
    ds_read_b64_tr_b16 v[138:139], v9 offset:21056
    ds_read_b64_tr_b16 v[140:141], v9 offset:20576
    ds_read_b64_tr_b16 v[142:143], v9 offset:21088
    s_waitcnt lgkmcnt(8)
    v_mfma_f32_16x16x32_bf16 v[176:179], v[112:115], v[64:67], v[176:179]
    v_mfma_f32_16x16x32_bf16 v[180:183], v[116:119], v[64:67], v[180:183]
    v_mfma_f32_16x16x32_bf16 v[184:187], v[120:123], v[64:67], v[184:187]
    v_mfma_f32_16x16x32_bf16 v[188:191], v[124:127], v[64:67], v[188:191]
    s_waitcnt vmcnt(29)
    ds_read_b64_tr_b16 v[112:113], v9 offset:24576
    ds_read_b64_tr_b16 v[114:115], v9 offset:25088
    ds_read_b64_tr_b16 v[116:117], v9 offset:24608
    ds_read_b64_tr_b16 v[118:119], v9 offset:25120
    ds_read_b64_tr_b16 v[120:121], v9 offset:24640
    ds_read_b64_tr_b16 v[122:123], v9 offset:25152
    ds_read_b64_tr_b16 v[124:125], v9 offset:24672
    ds_read_b64_tr_b16 v[126:127], v9 offset:25184
    s_waitcnt lgkmcnt(8)
    v_mfma_f32_16x16x32_bf16 v[176:179], v[128:131], v[68:71], v[176:179]
    v_mfma_f32_16x16x32_bf16 v[180:183], v[132:135], v[68:71], v[180:183]
    v_mfma_f32_16x16x32_bf16 v[184:187], v[136:139], v[68:71], v[184:187]
    v_mfma_f32_16x16x32_bf16 v[188:191], v[140:143], v[68:71], v[188:191]
    s_waitcnt vmcnt(25)
    ds_read_b64_tr_b16 v[128:129], v9 offset:28672
    ds_read_b64_tr_b16 v[130:131], v9 offset:29184
    ds_read_b64_tr_b16 v[132:133], v9 offset:28704
    ds_read_b64_tr_b16 v[134:135], v9 offset:29216
    ds_read_b64_tr_b16 v[136:137], v9 offset:28736
    ds_read_b64_tr_b16 v[138:139], v9 offset:29248
    ds_read_b64_tr_b16 v[140:141], v9 offset:28768
    ds_read_b64_tr_b16 v[142:143], v9 offset:29280
    s_waitcnt lgkmcnt(8)
    v_mfma_f32_16x16x32_bf16 v[176:179], v[112:115], v[72:75], v[176:179]
    v_mfma_f32_16x16x32_bf16 v[180:183], v[116:119], v[72:75], v[180:183]
    v_mfma_f32_16x16x32_bf16 v[184:187], v[120:123], v[72:75], v[184:187]
    v_mfma_f32_16x16x32_bf16 v[188:191], v[124:127], v[72:75], v[188:191]
    s_waitcnt vmcnt(21)
    ds_read_b64_tr_b16 v[112:113], v9 offset:32768
    ds_read_b64_tr_b16 v[114:115], v9 offset:33280
    ds_read_b64_tr_b16 v[116:117], v9 offset:32800
    ds_read_b64_tr_b16 v[118:119], v9 offset:33312
    ds_read_b64_tr_b16 v[120:121], v9 offset:32832
    ds_read_b64_tr_b16 v[122:123], v9 offset:33344
    ds_read_b64_tr_b16 v[124:125], v9 offset:32864
    ds_read_b64_tr_b16 v[126:127], v9 offset:33376
    s_waitcnt lgkmcnt(8)
    v_mfma_f32_16x16x32_bf16 v[176:179], v[128:131], v[76:79], v[176:179]
    v_mfma_f32_16x16x32_bf16 v[180:183], v[132:135], v[76:79], v[180:183]
    v_mfma_f32_16x16x32_bf16 v[184:187], v[136:139], v[76:79], v[184:187]
    v_mfma_f32_16x16x32_bf16 v[188:191], v[140:143], v[76:79], v[188:191]
    s_waitcnt vmcnt(17)
    ds_read_b64_tr_b16 v[128:129], v9 offset:36864
    ds_read_b64_tr_b16 v[130:131], v9 offset:37376
    ds_read_b64_tr_b16 v[132:133], v9 offset:36896
    ds_read_b64_tr_b16 v[134:135], v9 offset:37408
    ds_read_b64_tr_b16 v[136:137], v9 offset:36928
    ds_read_b64_tr_b16 v[138:139], v9 offset:37440
    ds_read_b64_tr_b16 v[140:141], v9 offset:36960
    ds_read_b64_tr_b16 v[142:143], v9 offset:37472
    s_waitcnt lgkmcnt(8)
    v_mfma_f32_16x16x32_bf16 v[176:179], v[112:115], v[80:83], v[176:179]
    v_mfma_f32_16x16x32_bf16 v[180:183], v[116:119], v[80:83], v[180:183]
    v_mfma_f32_16x16x32_bf16 v[184:187], v[120:123], v[80:83], v[184:187]
    v_mfma_f32_16x16x32_bf16 v[188:191], v[124:127], v[80:83], v[188:191]
    s_waitcnt vmcnt(13)
    ds_read_b64_tr_b16 v[112:113], v9 offset:40960
    ds_read_b64_tr_b16 v[114:115], v9 offset:41472
    ds_read_b64_tr_b16 v[116:117], v9 offset:40992
    ds_read_b64_tr_b16 v[118:119], v9 offset:41504
    ds_read_b64_tr_b16 v[120:121], v9 offset:41024
    ds_read_b64_tr_b16 v[122:123], v9 offset:41536
    ds_read_b64_tr_b16 v[124:125], v9 offset:41056
    ds_read_b64_tr_b16 v[126:127], v9 offset:41568
    s_waitcnt lgkmcnt(8)
    v_mfma_f32_16x16x32_bf16 v[176:179], v[128:131], v[84:87], v[176:179]
    v_mfma_f32_16x16x32_bf16 v[180:183], v[132:135], v[84:87], v[180:183]
    v_mfma_f32_16x16x32_bf16 v[184:187], v[136:139], v[84:87], v[184:187]
    v_mfma_f32_16x16x32_bf16 v[188:191], v[140:143], v[84:87], v[188:191]
    s_waitcnt vmcnt(9)
    ds_read_b64_tr_b16 v[128:129], v9 offset:45056
    ds_read_b64_tr_b16 v[130:131], v9 offset:45568
    ds_read_b64_tr_b16 v[132:133], v9 offset:45088
    ds_read_b64_tr_b16 v[134:135], v9 offset:45600
    ds_read_b64_tr_b16 v[136:137], v9 offset:45120
    ds_read_b64_tr_b16 v[138:139], v9 offset:45632
    ds_read_b64_tr_b16 v[140:141], v9 offset:45152
    ds_read_b64_tr_b16 v[142:143], v9 offset:45664
    s_waitcnt lgkmcnt(8)
    v_mfma_f32_16x16x32_bf16 v[176:179], v[112:115], v[88:91], v[176:179]
    v_mfma_f32_16x16x32_bf16 v[180:183], v[116:119], v[88:91], v[180:183]
    v_mfma_f32_16x16x32_bf16 v[184:187], v[120:123], v[88:91], v[184:187]
    v_mfma_f32_16x16x32_bf16 v[188:191], v[124:127], v[88:91], v[188:191]
    s_waitcnt vmcnt(5)
    ds_read_b64_tr_b16 v[112:113], v9 offset:49152
    ds_read_b64_tr_b16 v[114:115], v9 offset:49664
    ds_read_b64_tr_b16 v[116:117], v9 offset:49184
    ds_read_b64_tr_b16 v[118:119], v9 offset:49696
    ds_read_b64_tr_b16 v[120:121], v9 offset:49216
    ds_read_b64_tr_b16 v[122:123], v9 offset:49728
    ds_read_b64_tr_b16 v[124:125], v9 offset:49248
    ds_read_b64_tr_b16 v[126:127], v9 offset:49760
    s_waitcnt lgkmcnt(8)
    v_mfma_f32_16x16x32_bf16 v[176:179], v[128:131], v[92:95], v[176:179]
    v_mfma_f32_16x16x32_bf16 v[180:183], v[132:135], v[92:95], v[180:183]
    v_mfma_f32_16x16x32_bf16 v[184:187], v[136:139], v[92:95], v[184:187]
    v_mfma_f32_16x16x32_bf16 v[188:191], v[140:143], v[92:95], v[188:191]
    s_waitcnt vmcnt(1)
    ds_read_b64_tr_b16 v[128:129], v9 offset:53248
    ds_read_b64_tr_b16 v[130:131], v9 offset:53760
    ds_read_b64_tr_b16 v[132:133], v9 offset:53280
    ds_read_b64_tr_b16 v[134:135], v9 offset:53792
    ds_read_b64_tr_b16 v[136:137], v9 offset:53312
    ds_read_b64_tr_b16 v[138:139], v9 offset:53824
    ds_read_b64_tr_b16 v[140:141], v9 offset:53344
    ds_read_b64_tr_b16 v[142:143], v9 offset:53856
    s_waitcnt lgkmcnt(8)
    v_mfma_f32_16x16x32_bf16 v[176:179], v[112:115], v[96:99], v[176:179]
    v_mfma_f32_16x16x32_bf16 v[180:183], v[116:119], v[96:99], v[180:183]
    v_mfma_f32_16x16x32_bf16 v[184:187], v[120:123], v[96:99], v[184:187]
    v_mfma_f32_16x16x32_bf16 v[188:191], v[124:127], v[96:99], v[188:191]
    s_waitcnt lgkmcnt(0)
    v_mfma_f32_16x16x32_bf16 v[176:179], v[128:131], v[100:103], v[176:179]
    v_mfma_f32_16x16x32_bf16 v[180:183], v[132:135], v[100:103], v[180:183]
    v_mfma_f32_16x16x32_bf16 v[184:187], v[136:139], v[100:103], v[184:187]
    v_mfma_f32_16x16x32_bf16 v[188:191], v[140:143], v[100:103], v[188:191]
    s_nop 7
    v_cndmask_b32 v32, v176, v184, s[64:65]
    v_cndmask_b32 v33, v177, v185, s[64:65]
    v_cndmask_b32 v34, v178, v186, s[64:65]
    v_cndmask_b32 v35, v179, v187, s[64:65]
    v_cvt_pk_bf16_f32 v16, v32, v33
    v_cvt_pk_bf16_f32 v18, v34, v35
    buffer_store_dwordx4 v[16:19], v10, s[28:31], s71 offen
    v_cndmask_b32 v32, v180, v188, s[64:65]
    v_cndmask_b32 v33, v181, v189, s[64:65]
    v_cndmask_b32 v34, v182, v190, s[64:65]
    v_cndmask_b32 v35, v183, v191, s[64:65]
    v_cvt_pk_bf16_f32 v20, v32, v33
    v_cvt_pk_bf16_f32 v22, v34, v35
    buffer_store_dwordx4 v[20:23], v10, s[28:31], s71 offen offset:128
    s_add_u32 s72, s71, 3145728
    buffer_store_dwordx4 v[16:19], v10, s[28:31], s72 offen sc1
    buffer_store_dwordx4 v[20:23], v10, s[28:31], s72 offen offset:128 sc1
M_noprod2:
    v_mov_b32 v15, 25856
    v_mov_b32 v12, 1
M_qpoll:
    s_and_b32 s71, s62, 3
    s_cmp_eq_u32 s71, 1
    s_cselect_b32 s71, 3145728, 0
    s_add_u32 s71, s71, s74
    buffer_load_dwordx4 v[48:51], v7, s[28:31], s71 offen offset:0 sc1
    buffer_load_dwordx4 v[52:55], v7, s[28:31], s71 offen offset:1024 sc1
    s_waitcnt vmcnt(0)
    v_xor_b32 v49, s52, v49
    v_xor_b32 v51, s52, v51
    v_xor_b32 v53, s52, v53
    v_xor_b32 v55, s52, v55
    v_or3_b32 v9, v49, v51, v53
    v_or_b32 v9, v9, v55
    v_cmp_ne_u32 vcc, 0, v9
    s_sub_u32 s62, s62, 1
    s_cmp_eq_u32 s62, 0
    s_cbranch_scc1 M_end
    s_cbranch_vccnz M_qpoll
    ds_write2_b32 v14, v48, v50 offset0:0 offset1:1
    ds_write2_b32 v14, v52, v54 offset0:128 offset1:129
    ds_write_b64 v15, v[12:13]
    s_setprio 0
    v_mov_b32 v8, 25856
    s_mov_b32 s75, 2097152
W_35:
    ds_read_b128 v[32:35], v8 offset:0
    s_sub_u32 s75, s75, 1
    s_cmp_eq_u32 s75, 0
    s_cbranch_scc1 M_end
    s_waitcnt lgkmcnt(0)
    v_readfirstlane_b32 s79, v35
    s_nop 0
    s_cmp_lg_u32 s79, 0
    s_cbranch_scc1 K_36
    s_sleep 1
    s_branch W_35
K_36:
    v_and_b32 v7, 31, v0
    v_lshlrev_b32 v7, 3, v7
M_xpoll:
    buffer_load_dwordx2 v[16:17], v7, s[28:31], s77 offen sc1
    s_waitcnt vmcnt(0)
    v_cmp_ne_u32 s[64:65], s63, v16
    v_cmp_ne_u32 vcc, s52, v17
    s_sub_u32 s62, s62, 1
    s_cmp_eq_u32 s62, 0
    s_cbranch_scc1 M_end
    s_cbranch_vccnz M_xpoll
    s_cmp_eq_u64 s[64:65], 0
    s_cselect_b32 s71, 2, 1
    v_mov_b32 v8, 25884
    v_mov_b32 v9, s71
    ds_write_b32 v8, v9
    s_cmp_ge_u32 s2, 224
    s_cbranch_scc1 M_fin
    s_barrier
    s_and_b32 s70, s2, 28
    s_add_u32 s70, s70, 96
    s_and_b32 s71, s2, 3
    s_lshl_b32 s72, s70, 12
    s_and_b32 s76, s71, 1
    s_lshl_b32 s76, s76, 9
    s_add_u32 s72, s72, s76
    s_lshr_b32 s76, s71, 1
    s_lshl_b32 s76, s76, 8
    s_add_u32 s72, s72, s76
    s_add_u32 s72, s72, 262144
    s_lshl_b32 s73, s70, 7
    s_lshr_b32 s71, s71, 1
    s_lshl_b32 s71, s71, 4
    s_add_u32 s73, s73, s71
    s_add_u32 s73, s73, 1310720
    v_lshlrev_b32 v14, 10, v47
    v_lshl_add_u32 v14, v46, 4, v14
    v_min_u32 v15, 11, v46
    v_lshrrev_b32 v13, 2, v15
    v_lshlrev_b32 v13, 12, v13
    v_and_b32 v15, 3, v15
    v_lshl_add_u32 v15, v15, 7, v13
    v_lshlrev_b32 v13, 4, v46
    v_lshl_add_u32 v13, v47, 2, v13
    s_not_b32 s71, s52
    v_mov_b32 v49, s71
    v_mov_b32 v53, s71
    v_mov_b32 v57, s71
    v_mov_b32 v61, s71
    v_mov_b32 v65, s71
    v_mov_b32 v69, s71
    v_mov_b32 v73, s71
    v_mov_b32 v77, s71
    v_mov_b32 v81, s71
    v_mov_b32 v85, s71
    v_mov_b32 v89, s71
    v_mov_b32 v93, s71
    v_mov_b32 v176, 0
    v_mov_b32 v177, s71
    v_mov_b32 v178, 1.0
    v_mov_b32 v179, s71
    s_mov_b32 s74, 0
    s_mov_b32 s57, 0
    s_mov_b32 s58, 0
    v_mov_b32 v8, 25856
    s_mov_b32 s75, 2097152
W_37:
    ds_read_b128 v[32:35], v8 offset:16
    s_sub_u32 s75, s75, 1
    s_cmp_eq_u32 s75, 0
    s_cbranch_scc1 M_end
    s_waitcnt lgkmcnt(0)
    v_readfirstlane_b32 s79, v32
    s_nop 0
    s_cmp_lg_u32 s79, 0
    s_cbranch_scc1 K_38
    s_sleep 1
    s_branch W_37
K_38:
G_39:
    s_andn2_b32 s71, 4095, s58
    s_mov_b32 exec_lo, s71
    s_mov_b32 exec_hi, 0
    buffer_load_dwordx4 v[176:179], v15, s[28:31], s73 offen sc1
    s_mov_b64 exec, -1
    s_bcnt1_i32_b32 s71, s71
    s_cmp_le_u32 s71, 16
    s_cselect_b32 s59, 4095, s58
    s_andn2_b32 s59, s59, s57
    s_bfe_u32 s71, s59, 262144
    s_cbranch_scc0 GS_40
    s_bitcmp1_b32 s59, 0
    s_cselect_b64 exec, -1, 0
    s_add_u32 s71, s72, 0
    buffer_load_dwordx4 v[48:51], v14, s[28:31], s71 offen sc1
    s_bitcmp1_b32 s59, 1
    s_cselect_b64 exec, -1, 0
    s_add_u32 s71, s72, 4096
    buffer_load_dwordx4 v[52:55], v14, s[28:31], s71 offen sc1
    s_bitcmp1_b32 s59, 2
    s_cselect_b64 exec, -1, 0
    s_add_u32 s71, s72, 8192
    buffer_load_dwordx4 v[56:59], v14, s[28:31], s71 offen sc1
    s_bitcmp1_b32 s59, 3
    s_cselect_b64 exec, -1, 0
    s_add_u32 s71, s72, 12288
    buffer_load_dwordx4 v[60:63], v14, s[28:31], s71 offen sc1
    s_mov_b64 exec, -1
GS_40:
    s_bfe_u32 s71, s59, 262148
    s_cbranch_scc0 GS_41
    s_bitcmp1_b32 s59, 4
    s_cselect_b64 exec, -1, 0
    s_add_u32 s71, s72, 131072
    buffer_load_dwordx4 v[64:67], v14, s[28:31], s71 offen sc1
    s_bitcmp1_b32 s59, 5
    s_cselect_b64 exec, -1, 0
    s_add_u32 s71, s72, 135168
    buffer_load_dwordx4 v[68:71], v14, s[28:31], s71 offen sc1
    s_bitcmp1_b32 s59, 6
    s_cselect_b64 exec, -1, 0
    s_add_u32 s71, s72, 139264
    buffer_load_dwordx4 v[72:75], v14, s[28:31], s71 offen sc1
    s_bitcmp1_b32 s59, 7
    s_cselect_b64 exec, -1, 0
    s_add_u32 s71, s72, 143360
    buffer_load_dwordx4 v[76:79], v14, s[28:31], s71 offen sc1
    s_mov_b64 exec, -1
GS_41:
    s_bfe_u32 s71, s59, 262152
    s_cbranch_scc0 GS_42
    s_bitcmp1_b32 s59, 8
    s_cselect_b64 exec, -1, 0
    s_add_u32 s71, s72, 262144
    buffer_load_dwordx4 v[80:83], v14, s[28:31], s71 offen sc1
    s_bitcmp1_b32 s59, 9
    s_cselect_b64 exec, -1, 0
    s_add_u32 s71, s72, 266240
    buffer_load_dwordx4 v[84:87], v14, s[28:31], s71 offen sc1
    s_bitcmp1_b32 s59, 10
    s_cselect_b64 exec, -1, 0
    s_add_u32 s71, s72, 270336
    buffer_load_dwordx4 v[88:91], v14, s[28:31], s71 offen sc1
    s_bitcmp1_b32 s59, 11
    s_cselect_b64 exec, -1, 0
    s_add_u32 s71, s72, 274432
    buffer_load_dwordx4 v[92:95], v14, s[28:31], s71 offen sc1
    s_mov_b64 exec, -1
GS_42:
    s_waitcnt vmcnt(0)
    v_xor_b32 v9, s52, v177
    v_xor_b32 v10, s52, v179
    v_or_b32 v9, v9, v10
    v_cmp_eq_u32 vcc, 0, v9
    v_max_f32_dpp v9, v176, v176 quad_perm:[1,0,3,2] row_mask:0xf bank_mask:0xf
    s_and_b32 s58, vcc_lo, 4095
    s_nop 0
    v_max_f32_dpp v9, v9, v9 quad_perm:[2,3,0,1] row_mask:0xf bank_mask:0xf
    v_sub_f32 v9, v176, v9
    v_exp_f32 v9, v9
    s_nop 0
    v_mul_f32 v10, v9, v178
    s_nop 1
    v_add_f32_dpp v10, v10, v10 quad_perm:[1,0,3,2] row_mask:0xf bank_mask:0xf
    s_nop 1
    v_add_f32_dpp v10, v10, v10 quad_perm:[2,3,0,1] row_mask:0xf bank_mask:0xf
    v_rcp_f32 v10, v10
    s_nop 0
    v_mul_f32 v12, v9, v10
    s_bitcmp1_b32 s74, 0
    s_cbranch_scc1 GB_43
    v_xor_b32 v32, s52, v49
    v_xor_b32 v33, s52, v51
    v_xor_b32 v34, s52, v53
    v_xor_b32 v35, s52, v55
    v_xor_b32 v36, s52, v57
    v_xor_b32 v37, s52, v59
    v_xor_b32 v38, s52, v61
    v_xor_b32 v39, s52, v63
    v_or_b32 v32, v32, v33
    v_or_b32 v34, v34, v35
    v_or_b32 v36, v36, v37
    v_or_b32 v38, v38, v39
    v_cmp_ne_u32 s[4:5], 0, v32
    v_cmp_ne_u32 s[6:7], 0, v34
    v_cmp_ne_u32 s[8:9], 0, v36
    v_cmp_ne_u32 s[10:11], 0, v38
    v_readlane_b32 s96, v12, 0
    v_readlane_b32 s97, v12, 1
    v_readlane_b32 s98, v12, 2
    v_readlane_b32 s99, v12, 3
    s_cmp_eq_u64 s[4:5], 0
    s_cselect_b32 s71, 1, 0
    s_or_b32 s57, s57, s71
    s_cmp_eq_u64 s[6:7], 0
    s_cselect_b32 s71, 2, 0
    s_or_b32 s57, s57, s71
    s_cmp_eq_u64 s[8:9], 0
    s_cselect_b32 s71, 4, 0
    s_or_b32 s57, s57, s71
    s_cmp_eq_u64 s[10:11], 0
    s_cselect_b32 s71, 8, 0
    s_or_b32 s57, s57, s71
    v_mul_f32 v10, s96, v48
    v_mul_f32 v11, s96, v50
    s_and_b32 s71, s57, s58
    s_bfe_u32 s71, s71, 262144
    s_cmp_lg_u32 s71, 15
    s_cbranch_scc1 GB_43
    v_fmac_f32 v10, s97, v52
    v_fmac_f32 v11, s97, v54
    v_fmac_f32 v10, s98, v56
    v_fmac_f32 v11, s98, v58
    v_fmac_f32 v10, s99, v60
    v_fmac_f32 v11, s99, v62
    v_cvt_pk_bf16_f32 v10, v10, v11
    ds_write_b32 v13, v10 offset:24368
    s_bitset1_b32 s74, 0
GB_43:
    s_bitcmp1_b32 s74, 1
    s_cbranch_scc1 GB_44
    v_xor_b32 v32, s52, v65
    v_xor_b32 v33, s52, v67
    v_xor_b32 v34, s52, v69
    v_xor_b32 v35, s52, v71
    v_xor_b32 v36, s52, v73
    v_xor_b32 v37, s52, v75
    v_xor_b32 v38, s52, v77
    v_xor_b32 v39, s52, v79
    v_or_b32 v32, v32, v33
    v_or_b32 v34, v34, v35
    v_or_b32 v36, v36, v37
    v_or_b32 v38, v38, v39
    v_cmp_ne_u32 s[4:5], 0, v32
    v_cmp_ne_u32 s[6:7], 0, v34
    v_cmp_ne_u32 s[8:9], 0, v36
    v_cmp_ne_u32 s[10:11], 0, v38
    v_readlane_b32 s96, v12, 4
    v_readlane_b32 s97, v12, 5
    v_readlane_b32 s98, v12, 6
    v_readlane_b32 s99, v12, 7
    s_cmp_eq_u64 s[4:5], 0
    s_cselect_b32 s71, 16, 0
    s_or_b32 s57, s57, s71
    s_cmp_eq_u64 s[6:7], 0
    s_cselect_b32 s71, 32, 0
    s_or_b32 s57, s57, s71
    s_cmp_eq_u64 s[8:9], 0
    s_cselect_b32 s71, 64, 0
    s_or_b32 s57, s57, s71
    s_cmp_eq_u64 s[10:11], 0
    s_cselect_b32 s71, 128, 0
    s_or_b32 s57, s57, s71
    v_mul_f32 v10, s96, v64
    v_mul_f32 v11, s96, v66
    s_and_b32 s71, s57, s58
    s_bfe_u32 s71, s71, 262148
    s_cmp_lg_u32 s71, 15
    s_cbranch_scc1 GB_44
    v_fmac_f32 v10, s97, v68
    v_fmac_f32 v11, s97, v70
    v_fmac_f32 v10, s98, v72
    v_fmac_f32 v11, s98, v74
    v_fmac_f32 v10, s99, v76
    v_fmac_f32 v11, s99, v78
    v_cvt_pk_bf16_f32 v10, v10, v11
    ds_write_b32 v13, v10 offset:24640
    s_bitset1_b32 s74, 1
GB_44:
    s_bitcmp1_b32 s74, 2
    s_cbranch_scc1 GB_45
    v_xor_b32 v32, s52, v81
    v_xor_b32 v33, s52, v83
    v_xor_b32 v34, s52, v85
    v_xor_b32 v35, s52, v87
    v_xor_b32 v36, s52, v89
    v_xor_b32 v37, s52, v91
    v_xor_b32 v38, s52, v93
    v_xor_b32 v39, s52, v95
    v_or_b32 v32, v32, v33
    v_or_b32 v34, v34, v35
    v_or_b32 v36, v36, v37
    v_or_b32 v38, v38, v39
    v_cmp_ne_u32 s[4:5], 0, v32
    v_cmp_ne_u32 s[6:7], 0, v34
    v_cmp_ne_u32 s[8:9], 0, v36
    v_cmp_ne_u32 s[10:11], 0, v38
    v_readlane_b32 s96, v12, 8
    v_readlane_b32 s97, v12, 9
    v_readlane_b32 s98, v12, 10
    v_readlane_b32 s99, v12, 11
    s_cmp_eq_u64 s[4:5], 0
    s_cselect_b32 s71, 256, 0
    s_or_b32 s57, s57, s71
    s_cmp_eq_u64 s[6:7], 0
    s_cselect_b32 s71, 512, 0
    s_or_b32 s57, s57, s71
    s_cmp_eq_u64 s[8:9], 0
    s_cselect_b32 s71, 1024, 0
    s_or_b32 s57, s57, s71
    s_cmp_eq_u64 s[10:11], 0
    s_cselect_b32 s71, 2048, 0
    s_or_b32 s57, s57, s71
    v_mul_f32 v10, s96, v80
    v_mul_f32 v11, s96, v82
    s_and_b32 s71, s57, s58
    s_bfe_u32 s71, s71, 262152
    s_cmp_lg_u32 s71, 15
    s_cbranch_scc1 GB_45
    v_fmac_f32 v10, s97, v84
    v_fmac_f32 v11, s97, v86
    v_fmac_f32 v10, s98, v88
    v_fmac_f32 v11, s98, v90
    v_fmac_f32 v10, s99, v92
    v_fmac_f32 v11, s99, v94
    v_cvt_pk_bf16_f32 v10, v10, v11
    ds_write_b32 v13, v10 offset:24912
    s_bitset1_b32 s74, 2
GB_45:
    s_sub_u32 s62, s62, 1
    s_cmp_eq_u32 s62, 0
    s_cbranch_scc1 M_end
    s_cmp_lg_u32 s74, 7
    s_cbranch_scc1 G_39
    v_mov_b32 v8, 25880
    v_mov_b32 v9, 1
    ds_write_b32 v8, v9
M_fin:
M_end:
    s_endpgm
.section .rodata,"a"
.p2align 6
.amdhsa_kernel standalone__gqa_block_cached__sampling_kernel
  .amdhsa_next_free_vgpr 388
  .amdhsa_next_free_sgpr 100
  .amdhsa_accum_offset 228
  .amdhsa_group_segment_fixed_size 0
  .amdhsa_kernarg_size 64
  .amdhsa_user_sgpr_count 2
  .amdhsa_user_sgpr_kernarg_segment_ptr 1
  .amdhsa_system_sgpr_workgroup_id_x 1
  .amdhsa_float_denorm_mode_32 3
.end_amdhsa_kernel
```
